```python
import torch

def _softmax(x, axis=-1):
    return torch.softmax(x, dim=axis)
def _gelu(x):
    return torch.nn.functional.gelu(x, approximate="tanh")
def _silu(x):
    return torch.nn.functional.silu(x)
def _sigmoid(x):
    return torch.sigmoid(x)
def _layernorm(x, axis=-1, eps=1e-5):
    m = x.mean(dim=axis, keepdim=True)
    v = x.var(dim=axis, keepdim=True, unbiased=False)
    return (x - m) / torch.sqrt(v + eps)
def _scatter_add(tgt, idx, src, axis=0):
    return tgt.clone().index_add_(axis, idx, src)
def _segment_sum(src, seg, n):
    out = torch.zeros((n,) + src.shape[1:], dtype=src.dtype)
    return out.index_add_(0, seg, src)
def _pad(x, pw):
    flat = tuple(v for pair in reversed(pw) for v in pair)
    return torch.nn.functional.pad(x, flat)

kernel_name = 'sequential_preLN__softmax_full_mha__glu_gated_glu__prompt'

def setup_inputs():

    _w = (lambda a: (lambda t: t.to(torch.bfloat16) if t.is_floating_point() else t)(torch.as_tensor(a)))
    def _A_setup():
        B, S, D = 1, 2048, 448
        return {
            "x": _w((lambda *s: torch.randn(*s, dtype=torch.bfloat16) * 0.05)(B, S, D)),
            "wqkv": _w((lambda *s: torch.randn(*s, dtype=torch.bfloat16) * 0.05)(D, 3 * D)),
            "wo": _w((lambda *s: torch.randn(*s, dtype=torch.bfloat16) * 0.05)(D, D)),
        }
    _A_in = _A_setup()

    def _B_setup():
        B, S, D, F = 1, 2048, 448, 1792
        return {
            "x": _w((lambda *s: torch.randn(*s, dtype=torch.bfloat16) * 0.05)(B, S, D)),
            "w_gate": _w((lambda *s: torch.randn(*s, dtype=torch.bfloat16) * 0.05)(D, F)),
            "w_up": _w((lambda *s: torch.randn(*s, dtype=torch.bfloat16) * 0.05)(D, F)),
            "w_down": _w((lambda *s: torch.randn(*s, dtype=torch.bfloat16) * 0.05)(F, D)),
        }
    _B_in = _B_setup()

    return {
        "A_x": _A_in["x"],
        "A_wqkv": _A_in["wqkv"],
        "A_wo": _A_in["wo"],
        "B_x": _B_in["x"],
        "B_w_gate": _B_in["w_gate"],
        "B_w_up": _B_in["w_up"],
        "B_w_down": _B_in["w_down"],
    }

def reference(A_x, A_wqkv, A_wo, B_x, B_w_gate, B_w_up, B_w_down):
    def _A_ref(x, wqkv, wo):
        B, S, D = x.shape
        H = 16; Dh = D // H
        qkv = (lambda x, *d: x.permute(*d))((x @ wqkv).reshape(B, S, 3, H, Dh), 2, 0, 3, 1, 4)
        q, k, v = qkv[0], qkv[1], qkv[2]
        scale = Dh ** -0.5
        scores = torch.einsum("bhqd,bhkd->bhqk", q, k) * scale
        p = _softmax(scores, axis=-1)
        o = torch.einsum("bhqk,bhkd->bhqd", p, v)
        return (lambda x, *d: x.permute(*d))(o, 0, 2, 1, 3).reshape(B, S, D) @ wo

    def _B_ref(x, w_gate, w_up, w_down):
        g = torch.einsum("bsd,df->bsf", x, w_gate)
        u = torch.einsum("bsd,df->bsf", x, w_up)
        h = _sigmoid(g) * u
        return torch.einsum("bsf,fd->bsd", h, w_down)

    x = A_x
    h = x + _A_ref(_layernorm(x, axis=-1), A_wqkv, A_wo)
    h2 = h + _B_ref(_layernorm(h, axis=-1), B_w_gate, B_w_up, B_w_down)
    return h2
```

```asm
; @launch grid=(256,1,1) block=(256,1,1) lds=163840
.amdgcn_target "amdgcn-amd-amdhsa--gfx950"
.text
.p2align 12
.fill 832, 4, 0xbf810000
.globl sequential_preLN__softmax_full_mha__glu_gated_glu__prompt_kernel
.p2align 8
.type sequential_preLN__softmax_full_mha__glu_gated_glu__prompt_kernel,@function
sequential_preLN__softmax_full_mha__glu_gated_glu__prompt_kernel:
    s_cmp_ge_u32 s2, 256
    s_cbranch_scc1 sequential_preLN__softmax_full_mha__glu_gated_glu__prompt_kernel_exit
    s_load_dwordx2 s[8:9], s[0:1], 0
    s_load_dwordx2 s[12:13], s[0:1], 8
    s_load_dwordx2 s[32:33], s[0:1], 72
    s_load_dwordx2 s[16:17], s[0:1], 16
    s_load_dwordx2 s[20:21], s[0:1], 32
    s_load_dwordx2 s[4:5], s[0:1], 40
    s_load_dwordx2 s[24:25], s[0:1], 48
    s_load_dwordx2 s[28:29], s[0:1], 56
    s_getpc_b64 s[56:57]
sequential_preLN__softmax_full_mha__glu_gated_glu__prompt_kernel_pc0:
    s_lshr_b32 s58, s2, 3
    s_mul_i32 s58, s58, 12
    v_lshrrev_b32 v4, 6, v0
    v_and_b32 v5, 63, v0
    v_min_u32 v5, 2, v5
    v_mad_u32_u24 v4, v4, 3, v5
    v_add_u32 v4, s58, v4
    v_lshlrev_b32 v4, 7, v4
    v_min_u32 v4, sequential_preLN__softmax_full_mha__glu_gated_glu__prompt_kernel_exit-sequential_preLN__softmax_full_mha__glu_gated_glu__prompt_kernel_pc0, v4
    global_load_dword v250, v4, s[56:57]
    v_readfirstlane_b32 s3, v0
    v_and_b32 v1, 63, v0
    s_and_b32 s6, s2, 7
    s_lshr_b32 s7, s2, 3
    s_lshr_b32 s3, s3, 6
    s_and_b32 s48, s7, 1
    s_lshr_b32 s49, s7, 1
    s_lshl_b32 s45, s6, 21
    s_mov_b32 s10, 1835008
    s_mov_b32 s11, 0x20000
    s_mov_b32 s14, 1204224
    s_mov_b32 s15, 0x20000
    s_mov_b32 s34, 22020096
    s_mov_b32 s35, 0x20000
    s_lshl_b32 s62, s49, 2
    s_add_u32 s62, s62, s3
    s_mul_i32 s50, s62, 28672
    s_mul_i32 s52, s3, 43008
    s_mul_i32 s51, s6, 112
    s_add_u32 s52, s52, s51
    s_mul_i32 s51, s48, 896
    s_add_u32 s51, s51, s52
    s_add_u32 s51, s51, 896
    s_mul_i32 s53, s48, 48
    s_add_u32 s52, s52, s53
    s_mul_i32 s53, s3, 24576
    s_add_u32 s53, s53, 65536
    s_lshl_b32 s54, s3, 11
    v_lshrrev_b32 v4, 3, v1
    v_lshrrev_b32 v5, 4, v1
    v_and_b32 v6, 7, v1
    v_mul_u32_u24 v7, 896, v4
    v_xor_b32 v5, v5, v6
    v_lshl_add_u32 v208, v5, 4, v7
    v_xor_b32 v5, 4, v5
    v_lshl_add_u32 v209, v5, 4, v7
    v_add_u32 v210, 12288, v208
    v_add_u32 v211, 18432, v209
    v_add_u32 v209, 6144, v209
    v_lshrrev_b32 v5, 2, v1
    v_and_b32 v5, 4, v5
    v_xor_b32 v5, v5, v6
    v_min_u32 v5, 6, v5
    v_mul_u32_u24 v7, 2688, v4
    v_lshl_add_u32 v212, v5, 4, v7
    v_add_u32 v213, 20480, v212
    s_add_u32 s61, s45, 819072
    s_cmp_eq_u32 s3, 0
    s_cselect_b32 s56, 27, 0
    v_lshl_add_u32 v4, v1, 7, s61
    v_cmp_gt_u32 vcc, s56, v1
    v_mov_b32 v5, 1073741824
    s_nop 0
    v_cndmask_b32 v4, v5, v4, vcc
    v_cmp_eq_u32 vcc, 0, v1
    v_mov_b32 v6, 18874380
    s_nop 0
    v_cndmask_b32 v4, v4, v6, vcc
    v_cndmask_b32 v31, v5, 0, vcc
    s_mul_i32 s58, s6, 1
    s_mul_i32 s56, s48, 0
    s_add_u32 s58, s58, s56
    s_mul_i32 s56, s49, 1
    s_add_u32 s58, s58, s56
    s_mul_i32 s56, s58, 147
    s_lshr_b32 s56, s56, 10
    s_mul_i32 s56, s56, 7
    s_sub_u32 s58, s58, s56
    s_lshl_b32 s56, s58, 7
    s_add_u32 s50, s50, s56
    s_mul_i32 s56, s58, 172032
    s_add_u32 s51, s51, s56
    s_add_u32 s52, s52, s56
    s_mov_b32 s59, 172032
    s_mov_b32 s60, 128
    s_mov_b32 m0, s53
    s_waitcnt lgkmcnt(0)
    buffer_load_dword v30, v4, s[32:35], 0 offen sc1
    buffer_load_dwordx4 v208, s[8:11], s50 offen offset:0 lds
    buffer_load_dwordx4 v209, s[8:11], s50 offen offset:1024 lds
    buffer_load_dwordx4 v210, s[8:11], s50 offen offset:2048 lds
    buffer_load_dwordx4 v211, s[8:11], s50 offen offset:3072 lds
    s_add_u32 m0, s54, 0
    s_cmp_eq_u32 s58, 6
    s_cselect_b32 s57, -768, s60
    s_add_u32 s50, s50, s57
    buffer_load_dwordx4 v212, s[12:15], s51 offen offset:0 lds
    buffer_load_dwordx4 v213, s[12:15], s51 offen offset:1024 lds
    s_add_u32 m0, s53, 4096
    s_cmp_eq_u32 s58, 6
    s_cselect_b32 s57, -1032192, s59
    s_add_u32 s51, s51, s57
    buffer_load_dwordx4 v208, s[8:11], s50 offen offset:0 lds
    buffer_load_dwordx4 v209, s[8:11], s50 offen offset:1024 lds
    buffer_load_dwordx4 v210, s[8:11], s50 offen offset:2048 lds
    buffer_load_dwordx4 v211, s[8:11], s50 offen offset:3072 lds
    s_add_u32 m0, s54, 8192
    s_cmp_eq_u32 s58, 5
    s_cselect_b32 s57, -768, s60
    s_add_u32 s50, s50, s57
    s_cmp_eq_u32 s3, 1
    s_cselect_b32 s40, s4, s20
    s_cselect_b32 s41, s5, s21
    s_cmp_eq_u32 s3, 2
    s_cselect_b32 s40, s24, s40
    s_cselect_b32 s41, s25, s41
    s_cmp_eq_u32 s3, 3
    s_cselect_b32 s40, s16, s40
    s_cselect_b32 s41, s17, s41
    s_mov_b32 s42, 1605632
    s_cselect_b32 s42, 401408, s42
    s_mov_b32 s43, 0x20000
    s_cselect_b32 s56, 13, 49
    s_mul_i32 s57, s56, s2
    s_sub_u32 s56, s56, 1
    v_min_u32 v215, s56, v1
    v_add_u32 v215, s57, v215
    v_lshlrev_b32 v215, 7, v215
    s_bitcmp1_b32 s3, 0
    s_cselect_b32 s20, s4, s20
    s_cselect_b32 s21, s5, s21
    s_mov_b32 s18, 401408
    s_mov_b32 s19, 0x20000
    s_mov_b32 s22, 1605632
    s_mov_b32 s23, 0x20000
    s_mov_b32 s26, 1605632
    s_mov_b32 s27, 0x20000
    s_mov_b32 s30, 1835008
    s_mov_b32 s31, 0x20000
    s_mov_b32 s36, s32
    s_mov_b32 s37, s33
    s_mov_b32 s38, 0
    s_mov_b32 s39, 0x20000
    s_mov_b32 s46, 0
    s_mov_b32 s47, -1
    s_lshl_b32 s55, s62, 12
    s_lshl_b32 s4, s48, 11
    s_add_u32 s55, s55, s4
    s_add_u32 s55, s55, s45
    v_lshlrev_b32 v2, 4, v1
    v_lshrrev_b32 v4, 2, v1
    v_mul_u32_u24 v214, 2688, v4
    v_and_b32 v4, 3, v1
    v_lshl_add_u32 v214, v4, 4, v214
    v_and_b32 v5, 31, v1
    v_lshlrev_b32 v4, 7, v5
    v_add_u32 v4, s53, v4
    v_lshrrev_b32 v5, 5, v1
    v_bfe_u32 v6, v1, 1, 3
    v_xor_b32 v5, v5, v6
    v_bfe_u32 v7, v1, 2, 2
    v_lshlrev_b32 v6, 0, v7
    v_lshrrev_b32 v7, 5, v1
    v_lshl_add_u32 v6, v7, 3, v6
    v_bfe_u32 v0, v1, 4, 1
    v_lshlrev_b32 v7, 5, v0
    v_and_b32 v0, 3, v1
    v_lshl_add_u32 v7, v0, 3, v7
    v_bfe_u32 v0, v1, 3, 1
    v_lshlrev_b32 v232, 6, v0
    v_xor_b32 v234, v7, v232
    v_lshl_add_u32 v234, v6, 7, v234
    v_add_u32 v233, 56, v7
    v_xor_b32 v233, v233, v232
    v_lshl_add_u32 v233, v6, 7, v233
    s_lshl_b32 s4, s48, 3
    s_add_u32 s4, s4, 69632
    v_lshl_add_u32 v6, v6, 6, v7
    v_add_u32 v239, s53, v6
    v_add_u32 v6, s4, v6
    s_add_u32 s4, s3, 0
    s_and_b32 s4, s4, 3
    s_lshl_b32 s5, s4, 1
    v_xor_b32 v7, s5, v5
    s_lshl_b32 s5, s4, 11
    s_mul_i32 s4, s4, 24576
    v_lshl_add_u32 v216, v7, 4, v4
    v_add_u32 v220, s5, v234
    v_add_u32 v221, s5, v233
    v_add_u32 v228, s4, v6
    s_add_u32 s4, s3, 1
    s_and_b32 s4, s4, 3
    s_lshl_b32 s5, s4, 1
    v_xor_b32 v7, s5, v5
    s_lshl_b32 s5, s4, 11
    s_mul_i32 s4, s4, 24576
    v_lshl_add_u32 v217, v7, 4, v4
    v_add_u32 v222, s5, v234
    v_add_u32 v223, s5, v233
    v_add_u32 v229, s4, v6
    s_add_u32 s4, s3, 2
    s_and_b32 s4, s4, 3
    s_lshl_b32 s5, s4, 1
    v_xor_b32 v7, s5, v5
    s_lshl_b32 s5, s4, 11
    s_mul_i32 s4, s4, 24576
    v_lshl_add_u32 v218, v7, 4, v4
    v_add_u32 v224, s5, v234
    v_add_u32 v225, s5, v233
    v_add_u32 v230, s4, v6
    s_add_u32 s4, s3, 3
    s_and_b32 s4, s4, 3
    s_lshl_b32 s5, s4, 1
    v_xor_b32 v7, s5, v5
    s_lshl_b32 s5, s4, 11
    s_mul_i32 s4, s4, 24576
    v_lshl_add_u32 v219, v7, 4, v4
    v_add_u32 v226, s5, v234
    v_add_u32 v227, s5, v233
    v_add_u32 v231, s4, v6
    v_and_b32 v4, 15, v1
    v_lshlrev_b32 v232, 7, v4
    v_bfe_u32 v4, v1, 4, 1
    v_lshl_add_u32 v232, v4, 18, v232
    v_lshrrev_b32 v4, 5, v1
    v_lshl_add_u32 v232, v4, 30, v232
    v_and_b32 v4, 31, v1
    v_lshlrev_b32 v233, 2, v4
    v_lshrrev_b32 v4, 2, v1
    v_xor_b32 v4, v4, v1
    v_and_b32 v4, 4, v4
    v_cmp_eq_u32 vcc, 0, v4
    v_mov_b32 v4, 0x3f803f80
    s_nop 0
    v_cndmask_b32 v192, 0, v4, vcc
    v_mov_b32 v193, v192
    v_mov_b32 v194, v192
    v_mov_b32 v195, v192
    v_mov_b32 v197, 0
    v_mov_b32 v199, 0
    v_mov_b32 v200, 0
    v_mov_b32 v201, 0
    v_mov_b32 v202, 0
    v_mov_b32 v203, 0
    v_mov_b32 v205, 0
    v_mov_b32 v206, 0
    v_mov_b32 v207, 0
    v_lshlrev_b32 v236, 2, v1
    s_lshl_b32 s4, s3, 9
    v_add_u32 v237, s4, v236
    v_mov_b32 v3, 0xdddd
    v_mov_b32 v80, 0
    v_mov_b32 v81, 0
    v_mov_b32 v82, 0
    v_mov_b32 v83, 0
    v_mov_b32 v84, 0
    v_mov_b32 v85, 0
    v_mov_b32 v86, 0
    v_mov_b32 v87, 0
    v_mov_b32 v88, 0
    v_mov_b32 v89, 0
    v_mov_b32 v90, 0
    v_mov_b32 v91, 0
    v_mov_b32 v92, 0
    v_mov_b32 v93, 0
    v_mov_b32 v94, 0
    v_mov_b32 v95, 0
    v_mov_b32 v96, 0
    v_mov_b32 v97, 0
    v_mov_b32 v98, 0
    v_mov_b32 v99, 0
    v_mov_b32 v100, 0
    v_mov_b32 v101, 0
    v_mov_b32 v102, 0
    v_mov_b32 v103, 0
    v_mov_b32 v104, 0
    v_mov_b32 v105, 0
    v_mov_b32 v106, 0
    v_mov_b32 v107, 0
    v_mov_b32 v108, 0
    v_mov_b32 v109, 0
    v_mov_b32 v110, 0
    v_mov_b32 v111, 0
    v_mov_b32 v112, 0
    v_mov_b32 v113, 0
    v_mov_b32 v114, 0
    v_mov_b32 v115, 0
    v_mov_b32 v116, 0
    v_mov_b32 v117, 0
    v_mov_b32 v118, 0
    v_mov_b32 v119, 0
    v_mov_b32 v120, 0
    v_mov_b32 v121, 0
    v_mov_b32 v122, 0
    v_mov_b32 v123, 0
    v_mov_b32 v124, 0
    v_mov_b32 v125, 0
    v_mov_b32 v126, 0
    v_mov_b32 v127, 0
    v_mov_b32 v128, 0
    v_mov_b32 v129, 0
    v_mov_b32 v130, 0
    v_mov_b32 v131, 0
    v_mov_b32 v132, 0
    v_mov_b32 v133, 0
    v_mov_b32 v134, 0
    v_mov_b32 v135, 0
    v_mov_b32 v136, 0
    v_mov_b32 v137, 0
    v_mov_b32 v138, 0
    v_mov_b32 v139, 0
    v_mov_b32 v140, 0
    v_mov_b32 v141, 0
    v_mov_b32 v142, 0
    v_mov_b32 v143, 0
    v_lshrrev_b32 v4, 3, v1
    v_and_b32 v5, 6, v4
    v_and_b32 v6, 7, v1
    v_xor_b32 v5, v5, v6
    s_cmp_lt_u32 s7, 28
    s_cselect_b32 s5, 0, 1073741824
    v_mul_u32_u24 v7, 3584, v4
    v_or_b32 v7, s5, v7
    v_lshl_add_u32 v8, v5, 4, v7
    v_add_u32 v9, 27648, v8
    v_add_u32 v10, 55296, v8
    v_add_u32 v11, 82944, v8
    v_mul_u32_u24 v7, 896, v4
    v_or_b32 v7, s5, v7
    s_lshl_b32 s4, s3, 2
    s_add_u32 s4, s4, 0
    v_subrev_u32 v5, s4, v6
    v_and_b32 v5, 7, v5
    v_lshl_add_u32 v5, v5, 4, v7
    v_add_u32 v12, 0, v5
    s_lshl_b32 s4, s3, 2
    s_add_u32 s4, s4, 2
    v_subrev_u32 v5, s4, v6
    v_and_b32 v5, 7, v5
    v_lshl_add_u32 v5, v5, 4, v7
    v_add_u32 v13, 6144, v5
    s_lshl_b32 s4, s3, 2
    s_add_u32 s4, s4, 4
    v_subrev_u32 v5, s4, v6
    v_and_b32 v5, 7, v5
    v_lshl_add_u32 v5, v5, 4, v7
    v_add_u32 v14, 12288, v5
    s_lshl_b32 s4, s3, 2
    s_add_u32 s4, s4, 6
    v_subrev_u32 v5, s4, v6
    v_and_b32 v5, 7, v5
    v_lshl_add_u32 v5, v5, 4, v7
    v_add_u32 v15, 18432, v5
    v_lshrrev_b32 v5, 2, v1
    v_lshlrev_b32 v4, 7, v5
    v_and_b32 v5, 3, v1
    v_lshl_add_u32 v4, v5, 3, v4
    v_bfe_u32 v5, v1, 3, 2
    v_lshl_add_u32 v4, v5, 5, v4
    s_and_b32 s4, s3, 1
    s_lshl_b32 s4, s4, 6
    s_lshr_b32 s5, s3, 1
    s_lshl_b32 s5, s5, 13
    s_add_u32 s5, s5, 65536
    v_xor_b32 v4, s4, v4
    v_add_u32 v16, s5, v4
    v_xor_b32 v17, 32, v16
    v_add_u32 v18, 49152, v16
    v_add_u32 v19, 49152, v17
    v_lshrrev_b32 v5, 4, v1
    v_lshlrev_b32 v4, 7, v5
    v_bfe_u32 v5, v1, 2, 2
    v_lshl_add_u32 v4, v5, 10, v4
    v_and_b32 v5, 3, v1
    v_lshl_add_u32 v4, v5, 3, v4
    s_and_b32 s4, s3, 1
    s_mul_i32 s5, s4, 28672
    s_lshl_b32 s4, s4, 1
    s_add_u32 s56, s6, 1
    s_and_b32 s56, s56, 3
    s_sub_u32 s4, s4, s56
    s_mul_i32 s56, s56, 7168
    s_add_u32 s5, s5, s56
    v_add_u32 v4, s5, v4
    v_bfe_u32 v5, v1, 2, 2
    v_add_u32 v5, s4, v5
    v_add_u32 v6, 2, v5
    v_and_b32 v6, 3, v6
    v_lshl_add_u32 v20, v6, 5, v4
    v_add_u32 v6, 3, v5
    v_and_b32 v6, 3, v6
    v_lshl_add_u32 v21, v6, 5, v4
    v_add_u32 v6, 4, v5
    v_and_b32 v6, 3, v6
    v_lshl_add_u32 v22, v6, 5, v4
    v_add_u32 v6, 5, v5
    v_and_b32 v6, 3, v6
    v_lshl_add_u32 v23, v6, 5, v4
    s_xor_b32 s4, s3, 3
    s_mul_i32 s4, s4, 12288
    s_add_u32 s4, s4, 114688
    v_add_u32 v24, s4, v2
    s_xor_b32 s4, s3, 2
    s_mul_i32 s4, s4, 12288
    s_add_u32 s4, s4, 118784
    v_add_u32 v25, s4, v2
    s_xor_b32 s4, s3, 1
    s_mul_i32 s4, s4, 12288
    s_add_u32 s4, s4, 122880
    v_add_u32 v26, s4, v2
    s_mul_i32 s4, s3, 12288
    s_add_u32 s4, s4, 114688
    v_add_u32 v27, s4, v2
    v_and_b32 v4, 15, v1
    v_mul_u32_u24 v28, 896, v4
    v_bfe_u32 v4, v1, 4, 1
    v_lshl_add_u32 v28, v4, 5, v28
    v_lshrrev_b32 v4, 5, v1
    v_lshl_add_u32 v28, v4, 4, v28
    v_and_b32 v4, 15, v1
    v_lshlrev_b32 v29, 4, v4
    v_bfe_u32 v4, v1, 4, 1
    v_lshl_add_u32 v29, v4, 11, v29
    v_lshrrev_b32 v4, 5, v1
    v_lshl_add_u32 v29, v4, 8, v29
    v_add_u32 v0, 131072, v2
    s_lshl_b32 s4, s6, 1
    s_add_u32 s4, s4, s48
    s_lshl_b32 s5, s49, 4
    s_add_u32 s5, s5, s4
    s_lshl_b32 s5, s5, 7
    s_add_u32 s5, s5, 19922944
    s_cmp_eq_u32 s3, 0
    s_cselect_b32 s5, s5, 1073741824
    v_or_b32 v249, s5, v31
    s_lshl_b32 s4, s4, 1
    s_and_b32 s5, s3, 1
    s_add_u32 s4, s4, s5
    s_lshl_b32 s4, s4, 10
    s_add_u32 s4, s4, 19922944
    s_lshl_b32 s5, s6, 1
    s_add_u32 s5, s5, 2
    v_add_u32 v4, s5, v1
    v_and_b32 v4, 7, v4
    v_lshl_add_u32 v248, v4, 7, s4
    v_lshrrev_b32 v4, 3, v1
    v_lshl_add_u32 v248, v4, 27, v248
    buffer_load_dwordx4 v212, s[12:15], s51 offen offset:0 lds
    buffer_load_dwordx4 v213, s[12:15], s51 offen offset:1024 lds
    s_add_u32 m0, s53, 8192
    s_cmp_eq_u32 s58, 5
    s_cselect_b32 s57, -1032192, s59
    s_add_u32 s51, s51, s57
    s_mov_b64 exec, 0
    s_cmp_eq_u32 s3, 0
    s_cbranch_scc1 sequential_preLN__softmax_full_mha__glu_gated_glu__prompt_kernel_pg1
    s_cmp_eq_u32 s3, 1
    s_cbranch_scc1 sequential_preLN__softmax_full_mha__glu_gated_glu__prompt_kernel_pg2
    s_cmp_eq_u32 s3, 2
    s_cbranch_scc1 sequential_preLN__softmax_full_mha__glu_gated_glu__prompt_kernel_pg3
    s_branch sequential_preLN__softmax_full_mha__glu_gated_glu__prompt_kernel_pg4
sequential_preLN__softmax_full_mha__glu_gated_glu__prompt_kernel_tb1:
    s_mov_b64 exec, -1
    s_mov_b64 exec, 0
    s_cmp_eq_u32 s3, 0
    s_cbranch_scc1 sequential_preLN__softmax_full_mha__glu_gated_glu__prompt_kernel_pg5
    s_cmp_eq_u32 s3, 1
    s_cbranch_scc1 sequential_preLN__softmax_full_mha__glu_gated_glu__prompt_kernel_pg6
    s_cmp_eq_u32 s3, 2
    s_cbranch_scc1 sequential_preLN__softmax_full_mha__glu_gated_glu__prompt_kernel_pg7
    s_branch sequential_preLN__softmax_full_mha__glu_gated_glu__prompt_kernel_pg8
sequential_preLN__softmax_full_mha__glu_gated_glu__prompt_kernel_tb5:
    s_mov_b64 exec, -1
    s_waitcnt vmcnt(6)
    s_barrier
    ds_read_b128 a[0:3], v216 offset:0
    ds_read_b64_tr_b16 a[112:113], v220 offset:0
    ds_read_b64_tr_b16 a[114:115], v220 offset:512
    ds_read_b64_tr_b16 a[116:117], v221 offset:0
    ds_read_b64_tr_b16 a[118:119], v221 offset:512
    ds_read_b128 a[4:7], v217 offset:0
    ds_read_b64_tr_b16 a[120:121], v222 offset:0
    ds_read_b64_tr_b16 a[122:123], v222 offset:512
    ds_read_b64_tr_b16 a[124:125], v223 offset:0
    ds_read_b64_tr_b16 a[126:127], v223 offset:512
    v_readfirstlane_b32 s44, v30
    s_getreg_b32 s61, hwreg(HW_REG_XCC_ID, 0, 4)
    s_add_u32 s44, s44, 0x9e3779b9
    s_add_u32 s61, s61, s44
    s_lshl_b32 s4, s7, 2
    s_add_u32 s4, s4, s45
    s_add_u32 s4, s4, 819200
    v_mov_b32 v4, s61
    v_mov_b32 v30, s44
    buffer_store_dword v4, v31, s[32:35], s4 offen
    s_waitcnt lgkmcnt(5)
    v_mfma_f32_32x32x16_bf16 v[32:47], a[112:115], a[0:3], 0
    ds_read_b128 a[8:11], v218 offset:0
    ds_read_b64_tr_b16 a[128:129], v224 offset:0
    ds_read_b64_tr_b16 a[130:131], v224 offset:512
    ds_read_b64_tr_b16 a[132:133], v225 offset:0
    ds_read_b64_tr_b16 a[134:135], v225 offset:512
    buffer_load_dwordx4 v208, s[8:11], s50 offen offset:0 lds
    v_mfma_f32_16x16x32_bf16 v[152:155], v[192:195], a[0:3], 0
    ds_read_b128 a[12:15], v219 offset:0
    v_mfma_f32_4x4x4_16b_bf16 v[144:147], a[0:1], a[0:1], 0
    ds_read_b64_tr_b16 a[136:137], v226 offset:0
    v_mfma_f32_4x4x4_16b_bf16 v[148:151], a[2:3], a[2:3], 0
    ds_read_b64_tr_b16 a[138:139], v226 offset:512
    v_mfma_f32_16x16x32_bf16 v[156:159], v[192:195], a[112:115], 0
    ds_read_b64_tr_b16 a[140:141], v227 offset:0
    v_mfma_f32_16x16x32_bf16 v[160:163], v[192:195], a[116:119], 0
    ds_read_b64_tr_b16 a[142:143], v227 offset:512
    v_mfma_f32_32x32x16_bf16 v[48:63], a[116:119], a[0:3], 0
    buffer_load_dwordx4 v209, s[8:11], s50 offen offset:1024 lds
    s_waitcnt lgkmcnt(10)
    v_mfma_f32_32x32x16_bf16 v[32:47], a[120:123], a[4:7], v[32:47]
    buffer_load_dwordx4 v210, s[8:11], s50 offen offset:2048 lds
    v_mfma_f32_16x16x32_bf16 v[152:155], v[192:195], a[4:7], v[152:155]
    v_mfma_f32_4x4x4_16b_bf16 v[144:147], a[4:5], a[4:5], v[144:147]
    v_mfma_f32_4x4x4_16b_bf16 v[148:151], a[6:7], a[6:7], v[148:151]
    v_mfma_f32_32x32x16_bf16 v[48:63], a[124:127], a[4:7], v[48:63]
    buffer_load_dwordx4 v211, s[8:11], s50 offen offset:3072 lds
    s_add_u32 m0, s54, 16384
    s_cmp_eq_u32 s58, 4
    s_cselect_b32 s57, -768, s60
    s_add_u32 s50, s50, s57
    s_waitcnt lgkmcnt(5)
    v_mfma_f32_32x32x16_bf16 v[32:47], a[128:131], a[8:11], v[32:47]
    buffer_load_dwordx4 v212, s[12:15], s51 offen offset:0 lds
    v_mfma_f32_16x16x32_bf16 v[152:155], v[192:195], a[8:11], v[152:155]
    v_mfma_f32_4x4x4_16b_bf16 v[144:147], a[8:9], a[8:9], v[144:147]
    v_mfma_f32_4x4x4_16b_bf16 v[148:151], a[10:11], a[10:11], v[148:151]
    v_mfma_f32_32x32x16_bf16 v[48:63], a[132:135], a[8:11], v[48:63]
    buffer_load_dwordx4 v213, s[12:15], s51 offen offset:1024 lds
    s_add_u32 m0, s53, 12288
    s_cmp_eq_u32 s58, 4
    s_cselect_b32 s57, -1032192, s59
    s_add_u32 s51, s51, s57
    s_waitcnt lgkmcnt(0)
    v_mfma_f32_32x32x16_bf16 v[32:47], a[136:139], a[12:15], v[32:47]
    s_waitcnt vmcnt(7)
    s_barrier
    ds_read_b128 a[16:19], v216 offset:4096
    ds_read_b64_tr_b16 a[144:145], v220 offset:8192
    ds_read_b64_tr_b16 a[146:147], v220 offset:8704
    ds_read_b64_tr_b16 a[148:149], v221 offset:8192
    ds_read_b64_tr_b16 a[150:151], v221 offset:8704
    v_mfma_f32_16x16x32_bf16 v[152:155], v[192:195], a[12:15], v[152:155]
    ds_read_b128 a[20:23], v217 offset:4096
    v_mfma_f32_4x4x4_16b_bf16 v[144:147], a[12:13], a[12:13], v[144:147]
    ds_read_b64_tr_b16 a[152:153], v222 offset:8192
    v_mfma_f32_4x4x4_16b_bf16 v[148:151], a[14:15], a[14:15], v[148:151]
    ds_read_b64_tr_b16 a[154:155], v222 offset:8704
    v_mfma_f32_32x32x16_bf16 v[48:63], a[140:143], a[12:15], v[48:63]
    ds_read_b64_tr_b16 a[156:157], v223 offset:8192
    ds_read_b64_tr_b16 a[158:159], v223 offset:8704
    ds_read_b128 a[24:27], v218 offset:4096
    ds_read_b64_tr_b16 a[160:161], v224 offset:8192
    ds_read_b64_tr_b16 a[162:163], v224 offset:8704
    s_waitcnt lgkmcnt(8)
    v_mfma_f32_32x32x16_bf16 v[32:47], a[144:147], a[16:19], v[32:47]
    ds_read_b64_tr_b16 a[164:165], v225 offset:8192
    ds_read_b64_tr_b16 a[166:167], v225 offset:8704
    ds_read_b128 a[28:31], v219 offset:4096
    ds_read_b64_tr_b16 a[168:169], v226 offset:8192
    ds_read_b64_tr_b16 a[170:171], v226 offset:8704
    buffer_load_dwordx4 v208, s[8:11], s50 offen offset:0 lds
    v_mfma_f32_16x16x32_bf16 v[152:155], v[192:195], a[16:19], v[152:155]
    ds_read_b64_tr_b16 a[172:173], v227 offset:8192
    v_mfma_f32_4x4x4_16b_bf16 v[144:147], a[16:17], a[16:17], v[144:147]
    ds_read_b64_tr_b16 a[174:175], v227 offset:8704
    v_mfma_f32_4x4x4_16b_bf16 v[148:151], a[18:19], a[18:19], v[148:151]
    v_mfma_f32_16x16x32_bf16 v[156:159], v[192:195], a[144:147], v[156:159]
    v_mfma_f32_16x16x32_bf16 v[160:163], v[192:195], a[148:151], v[160:163]
    v_mfma_f32_32x32x16_bf16 v[48:63], a[148:151], a[16:19], v[48:63]
    buffer_load_dwordx4 v209, s[8:11], s50 offen offset:1024 lds
    s_waitcnt lgkmcnt(10)
    v_mfma_f32_32x32x16_bf16 v[32:47], a[152:155], a[20:23], v[32:47]
    buffer_load_dwordx4 v210, s[8:11], s50 offen offset:2048 lds
    v_mfma_f32_16x16x32_bf16 v[152:155], v[192:195], a[20:23], v[152:155]
    v_mfma_f32_4x4x4_16b_bf16 v[144:147], a[20:21], a[20:21], v[144:147]
    v_mfma_f32_4x4x4_16b_bf16 v[148:151], a[22:23], a[22:23], v[148:151]
    v_mfma_f32_32x32x16_bf16 v[48:63], a[156:159], a[20:23], v[48:63]
    buffer_load_dwordx4 v211, s[8:11], s50 offen offset:3072 lds
    s_add_u32 m0, s54, 24576
    s_cmp_eq_u32 s58, 3
    s_cselect_b32 s57, -768, s60
    s_add_u32 s50, s50, s57
    s_waitcnt lgkmcnt(5)
    v_mfma_f32_32x32x16_bf16 v[32:47], a[160:163], a[24:27], v[32:47]
    buffer_load_dwordx4 v212, s[12:15], s51 offen offset:0 lds
    v_mfma_f32_16x16x32_bf16 v[152:155], v[192:195], a[24:27], v[152:155]
    v_mfma_f32_4x4x4_16b_bf16 v[144:147], a[24:25], a[24:25], v[144:147]
    v_mfma_f32_4x4x4_16b_bf16 v[148:151], a[26:27], a[26:27], v[148:151]
    v_mfma_f32_32x32x16_bf16 v[48:63], a[164:167], a[24:27], v[48:63]
    buffer_load_dwordx4 v213, s[12:15], s51 offen offset:1024 lds
    s_add_u32 m0, s53, 16384
    s_cmp_eq_u32 s58, 3
    s_cselect_b32 s57, -1032192, s59
    s_add_u32 s51, s51, s57
    s_waitcnt lgkmcnt(0)
    v_mfma_f32_32x32x16_bf16 v[32:47], a[168:171], a[28:31], v[32:47]
    s_waitcnt vmcnt(6)
    s_barrier
    ds_read_b128 a[32:35], v216 offset:8192
    ds_read_b64_tr_b16 a[112:113], v220 offset:16384
    ds_read_b64_tr_b16 a[114:115], v220 offset:16896
    ds_read_b64_tr_b16 a[116:117], v221 offset:16384
    ds_read_b64_tr_b16 a[118:119], v221 offset:16896
    v_mfma_f32_16x16x32_bf16 v[152:155], v[192:195], a[28:31], v[152:155]
    ds_read_b128 a[36:39], v217 offset:8192
    v_mfma_f32_4x4x4_16b_bf16 v[144:147], a[28:29], a[28:29], v[144:147]
    ds_read_b64_tr_b16 a[120:121], v222 offset:16384
    v_mfma_f32_4x4x4_16b_bf16 v[148:151], a[30:31], a[30:31], v[148:151]
    ds_read_b64_tr_b16 a[122:123], v222 offset:16896
    v_mfma_f32_32x32x16_bf16 v[48:63], a[172:175], a[28:31], v[48:63]
    ds_read_b64_tr_b16 a[124:125], v223 offset:16384
    ds_read_b64_tr_b16 a[126:127], v223 offset:16896
    ds_read_b128 a[40:43], v218 offset:8192
    ds_read_b64_tr_b16 a[128:129], v224 offset:16384
    ds_read_b64_tr_b16 a[130:131], v224 offset:16896
    s_waitcnt lgkmcnt(8)
    v_mfma_f32_32x32x16_bf16 v[32:47], a[112:115], a[32:35], v[32:47]
    ds_read_b64_tr_b16 a[132:133], v225 offset:16384
    ds_read_b64_tr_b16 a[134:135], v225 offset:16896
    ds_read_b128 a[44:47], v219 offset:8192
    ds_read_b64_tr_b16 a[136:137], v226 offset:16384
    ds_read_b64_tr_b16 a[138:139], v226 offset:16896
    buffer_load_dwordx4 v208, s[8:11], s50 offen offset:0 lds
    v_mfma_f32_16x16x32_bf16 v[152:155], v[192:195], a[32:35], v[152:155]
    ds_read_b64_tr_b16 a[140:141], v227 offset:16384
    v_mfma_f32_4x4x4_16b_bf16 v[144:147], a[32:33], a[32:33], v[144:147]
    ds_read_b64_tr_b16 a[142:143], v227 offset:16896
    v_mfma_f32_4x4x4_16b_bf16 v[148:151], a[34:35], a[34:35], v[148:151]
    v_mfma_f32_16x16x32_bf16 v[156:159], v[192:195], a[112:115], v[156:159]
    v_mfma_f32_16x16x32_bf16 v[160:163], v[192:195], a[116:119], v[160:163]
    v_mfma_f32_32x32x16_bf16 v[48:63], a[116:119], a[32:35], v[48:63]
    buffer_load_dwordx4 v209, s[8:11], s50 offen offset:1024 lds
    s_waitcnt lgkmcnt(10)
    v_mfma_f32_32x32x16_bf16 v[32:47], a[120:123], a[36:39], v[32:47]
    buffer_load_dwordx4 v210, s[8:11], s50 offen offset:2048 lds
    v_mfma_f32_16x16x32_bf16 v[152:155], v[192:195], a[36:39], v[152:155]
    v_mfma_f32_4x4x4_16b_bf16 v[144:147], a[36:37], a[36:37], v[144:147]
    v_mfma_f32_4x4x4_16b_bf16 v[148:151], a[38:39], a[38:39], v[148:151]
    v_mfma_f32_32x32x16_bf16 v[48:63], a[124:127], a[36:39], v[48:63]
    buffer_load_dwordx4 v211, s[8:11], s50 offen offset:3072 lds
    s_add_u32 m0, s54, 32768
    s_cmp_eq_u32 s58, 2
    s_cselect_b32 s57, -768, s60
    s_add_u32 s50, s50, s57
    s_waitcnt lgkmcnt(5)
    v_mfma_f32_32x32x16_bf16 v[32:47], a[128:131], a[40:43], v[32:47]
    buffer_load_dwordx4 v212, s[12:15], s51 offen offset:0 lds
    v_mfma_f32_16x16x32_bf16 v[152:155], v[192:195], a[40:43], v[152:155]
    v_mfma_f32_4x4x4_16b_bf16 v[144:147], a[40:41], a[40:41], v[144:147]
    v_mfma_f32_4x4x4_16b_bf16 v[148:151], a[42:43], a[42:43], v[148:151]
    v_mfma_f32_32x32x16_bf16 v[48:63], a[132:135], a[40:43], v[48:63]
    buffer_load_dwordx4 v213, s[12:15], s51 offen offset:1024 lds
    s_add_u32 m0, s53, 20480
    s_cmp_eq_u32 s58, 2
    s_cselect_b32 s57, -1032192, s59
    s_add_u32 s51, s51, s57
    s_waitcnt lgkmcnt(0)
    v_mfma_f32_32x32x16_bf16 v[32:47], a[136:139], a[44:47], v[32:47]
    s_waitcnt vmcnt(6)
    s_barrier
    ds_read_b128 a[48:51], v216 offset:12288
    ds_read_b64_tr_b16 a[144:145], v220 offset:24576
    ds_read_b64_tr_b16 a[146:147], v220 offset:25088
    ds_read_b64_tr_b16 a[148:149], v221 offset:24576
    ds_read_b64_tr_b16 a[150:151], v221 offset:25088
    v_mfma_f32_16x16x32_bf16 v[152:155], v[192:195], a[44:47], v[152:155]
    ds_read_b128 a[52:55], v217 offset:12288
    v_mfma_f32_4x4x4_16b_bf16 v[144:147], a[44:45], a[44:45], v[144:147]
    ds_read_b64_tr_b16 a[152:153], v222 offset:24576
    v_mfma_f32_4x4x4_16b_bf16 v[148:151], a[46:47], a[46:47], v[148:151]
    ds_read_b64_tr_b16 a[154:155], v222 offset:25088
    v_mfma_f32_32x32x16_bf16 v[48:63], a[140:143], a[44:47], v[48:63]
    ds_read_b64_tr_b16 a[156:157], v223 offset:24576
    ds_read_b64_tr_b16 a[158:159], v223 offset:25088
    ds_read_b128 a[56:59], v218 offset:12288
    ds_read_b64_tr_b16 a[160:161], v224 offset:24576
    ds_read_b64_tr_b16 a[162:163], v224 offset:25088
    s_waitcnt lgkmcnt(8)
    v_mfma_f32_32x32x16_bf16 v[32:47], a[144:147], a[48:51], v[32:47]
    ds_read_b64_tr_b16 a[164:165], v225 offset:24576
    ds_read_b64_tr_b16 a[166:167], v225 offset:25088
    ds_read_b128 a[60:63], v219 offset:12288
    ds_read_b64_tr_b16 a[168:169], v226 offset:24576
    ds_read_b64_tr_b16 a[170:171], v226 offset:25088
    buffer_load_dwordx4 v208, s[8:11], s50 offen offset:0 lds
    v_mfma_f32_16x16x32_bf16 v[152:155], v[192:195], a[48:51], v[152:155]
sequential_preLN__softmax_full_mha__glu_gated_glu__prompt_kernel_pg1:
    s_cbranch_execz sequential_preLN__softmax_full_mha__glu_gated_glu__prompt_kernel_tb1
    ds_read_b64_tr_b16 a[172:173], v227 offset:24576
    v_mfma_f32_4x4x4_16b_bf16 v[144:147], a[48:49], a[48:49], v[144:147]
    ds_read_b64_tr_b16 a[174:175], v227 offset:25088
    v_mfma_f32_4x4x4_16b_bf16 v[148:151], a[50:51], a[50:51], v[148:151]
    v_mfma_f32_16x16x32_bf16 v[156:159], v[192:195], a[144:147], v[156:159]
    v_mfma_f32_16x16x32_bf16 v[160:163], v[192:195], a[148:151], v[160:163]
    v_mfma_f32_32x32x16_bf16 v[48:63], a[148:151], a[48:51], v[48:63]
    buffer_load_dwordx4 v209, s[8:11], s50 offen offset:1024 lds
    s_waitcnt lgkmcnt(10)
    v_mfma_f32_32x32x16_bf16 v[32:47], a[152:155], a[52:55], v[32:47]
    buffer_load_dwordx4 v210, s[8:11], s50 offen offset:2048 lds
    v_mfma_f32_16x16x32_bf16 v[152:155], v[192:195], a[52:55], v[152:155]
    v_mfma_f32_4x4x4_16b_bf16 v[144:147], a[52:53], a[52:53], v[144:147]
    v_mfma_f32_4x4x4_16b_bf16 v[148:151], a[54:55], a[54:55], v[148:151]
    v_mfma_f32_32x32x16_bf16 v[48:63], a[156:159], a[52:55], v[48:63]
    buffer_load_dwordx4 v211, s[8:11], s50 offen offset:3072 lds
    s_add_u32 m0, s54, 40960
    s_cmp_eq_u32 s58, 1
    s_cselect_b32 s57, -768, s60
    s_add_u32 s50, s50, s57
    s_waitcnt lgkmcnt(5)
    v_mfma_f32_32x32x16_bf16 v[32:47], a[160:163], a[56:59], v[32:47]
    buffer_load_dwordx4 v212, s[12:15], s51 offen offset:0 lds
    v_mfma_f32_16x16x32_bf16 v[152:155], v[192:195], a[56:59], v[152:155]
    v_mfma_f32_4x4x4_16b_bf16 v[144:147], a[56:57], a[56:57], v[144:147]
    v_mfma_f32_4x4x4_16b_bf16 v[148:151], a[58:59], a[58:59], v[148:151]
    v_mfma_f32_32x32x16_bf16 v[48:63], a[164:167], a[56:59], v[48:63]
    buffer_load_dwordx4 v213, s[12:15], s51 offen offset:1024 lds
    s_add_u32 m0, s53, 0
    s_cmp_eq_u32 s58, 1
    s_cselect_b32 s57, -1032192, s59
    s_add_u32 s51, s51, s57
    s_waitcnt lgkmcnt(0)
    v_mfma_f32_32x32x16_bf16 v[32:47], a[168:171], a[60:63], v[32:47]
    s_waitcnt vmcnt(6)
    s_barrier
    ds_read_b128 a[64:67], v216 offset:16384
    ds_read_b64_tr_b16 a[112:113], v220 offset:32768
    ds_read_b64_tr_b16 a[114:115], v220 offset:33280
    ds_read_b64_tr_b16 a[116:117], v221 offset:32768
    ds_read_b64_tr_b16 a[118:119], v221 offset:33280
    v_mfma_f32_16x16x32_bf16 v[152:155], v[192:195], a[60:63], v[152:155]
    ds_read_b128 a[68:71], v217 offset:16384
    v_mfma_f32_4x4x4_16b_bf16 v[144:147], a[60:61], a[60:61], v[144:147]
    ds_read_b64_tr_b16 a[120:121], v222 offset:32768
    v_mfma_f32_4x4x4_16b_bf16 v[148:151], a[62:63], a[62:63], v[148:151]
    ds_read_b64_tr_b16 a[122:123], v222 offset:33280
    v_mfma_f32_32x32x16_bf16 v[48:63], a[172:175], a[60:63], v[48:63]
    ds_read_b64_tr_b16 a[124:125], v223 offset:32768
    ds_read_b64_tr_b16 a[126:127], v223 offset:33280
    ds_read_b128 a[72:75], v218 offset:16384
    ds_read_b64_tr_b16 a[128:129], v224 offset:32768
    ds_read_b64_tr_b16 a[130:131], v224 offset:33280
    s_waitcnt lgkmcnt(8)
    v_mfma_f32_32x32x16_bf16 v[32:47], a[112:115], a[64:67], v[32:47]
    ds_read_b64_tr_b16 a[132:133], v225 offset:32768
    ds_read_b64_tr_b16 a[134:135], v225 offset:33280
    ds_read_b128 a[76:79], v219 offset:16384
    ds_read_b64_tr_b16 a[136:137], v226 offset:32768
    ds_read_b64_tr_b16 a[138:139], v226 offset:33280
    buffer_load_dwordx4 v208, s[8:11], s50 offen offset:0 lds
    v_mfma_f32_16x16x32_bf16 v[152:155], v[192:195], a[64:67], v[152:155]
    ds_read_b64_tr_b16 a[140:141], v227 offset:32768
    v_mfma_f32_4x4x4_16b_bf16 v[144:147], a[64:65], a[64:65], v[144:147]
    ds_read_b64_tr_b16 a[142:143], v227 offset:33280
    v_mfma_f32_4x4x4_16b_bf16 v[148:151], a[66:67], a[66:67], v[148:151]
    v_mfma_f32_16x16x32_bf16 v[156:159], v[192:195], a[112:115], v[156:159]
    v_mfma_f32_16x16x32_bf16 v[160:163], v[192:195], a[116:119], v[160:163]
    v_mfma_f32_32x32x16_bf16 v[48:63], a[116:119], a[64:67], v[48:63]
    buffer_load_dwordx4 v209, s[8:11], s50 offen offset:1024 lds
    s_waitcnt lgkmcnt(10)
    v_mfma_f32_32x32x16_bf16 v[32:47], a[120:123], a[68:71], v[32:47]
    buffer_load_dwordx4 v210, s[8:11], s50 offen offset:2048 lds
    v_mfma_f32_16x16x32_bf16 v[152:155], v[192:195], a[68:71], v[152:155]
    v_mfma_f32_4x4x4_16b_bf16 v[144:147], a[68:69], a[68:69], v[144:147]
    v_mfma_f32_4x4x4_16b_bf16 v[148:151], a[70:71], a[70:71], v[148:151]
    v_mfma_f32_32x32x16_bf16 v[48:63], a[124:127], a[68:71], v[48:63]
    buffer_load_dwordx4 v211, s[8:11], s50 offen offset:3072 lds
    s_add_u32 m0, s54, 49152
    s_waitcnt lgkmcnt(5)
    v_mfma_f32_32x32x16_bf16 v[32:47], a[128:131], a[72:75], v[32:47]
    buffer_load_dwordx4 v212, s[12:15], s51 offen offset:0 lds
    v_mfma_f32_16x16x32_bf16 v[152:155], v[192:195], a[72:75], v[152:155]
    v_mfma_f32_4x4x4_16b_bf16 v[144:147], a[72:73], a[72:73], v[144:147]
    v_mfma_f32_4x4x4_16b_bf16 v[148:151], a[74:75], a[74:75], v[148:151]
    v_mfma_f32_32x32x16_bf16 v[48:63], a[132:135], a[72:75], v[48:63]
    buffer_load_dwordx4 v213, s[12:15], s51 offen offset:1024 lds
    s_add_u32 m0, s53, 4096
    s_waitcnt lgkmcnt(0)
    v_mfma_f32_32x32x16_bf16 v[32:47], a[136:139], a[76:79], v[32:47]
    s_waitcnt vmcnt(6)
    s_barrier
    ds_read_b128 a[80:83], v216 offset:20480
    ds_read_b64_tr_b16 a[144:145], v220 offset:40960
    ds_read_b64_tr_b16 a[146:147], v220 offset:41472
    ds_read_b64_tr_b16 a[148:149], v221 offset:40960
    ds_read_b64_tr_b16 a[150:151], v221 offset:41472
    v_mfma_f32_16x16x32_bf16 v[152:155], v[192:195], a[76:79], v[152:155]
    ds_read_b128 a[84:87], v217 offset:20480
    v_mfma_f32_4x4x4_16b_bf16 v[144:147], a[76:77], a[76:77], v[144:147]
    ds_read_b64_tr_b16 a[152:153], v222 offset:40960
    v_mfma_f32_4x4x4_16b_bf16 v[148:151], a[78:79], a[78:79], v[148:151]
    ds_read_b64_tr_b16 a[154:155], v222 offset:41472
    v_mfma_f32_32x32x16_bf16 v[48:63], a[140:143], a[76:79], v[48:63]
    ds_read_b64_tr_b16 a[156:157], v223 offset:40960
    ds_read_b64_tr_b16 a[158:159], v223 offset:41472
    ds_read_b128 a[88:91], v218 offset:20480
    ds_read_b64_tr_b16 a[160:161], v224 offset:40960
    ds_read_b64_tr_b16 a[162:163], v224 offset:41472
    s_waitcnt lgkmcnt(8)
    v_mfma_f32_32x32x16_bf16 v[32:47], a[144:147], a[80:83], v[32:47]
    ds_read_b64_tr_b16 a[164:165], v225 offset:40960
    ds_read_b64_tr_b16 a[166:167], v225 offset:41472
    ds_read_b128 a[92:95], v219 offset:20480
    ds_read_b64_tr_b16 a[168:169], v226 offset:40960
    ds_read_b64_tr_b16 a[170:171], v226 offset:41472
    s_add_u32 s56, s45, 819200
    buffer_load_dword v234, v233, s[32:35], s56 offen offset:0 sc1
    v_mfma_f32_16x16x32_bf16 v[152:155], v[192:195], a[80:83], v[152:155]
    ds_read_b64_tr_b16 a[172:173], v227 offset:40960
    v_mfma_f32_4x4x4_16b_bf16 v[144:147], a[80:81], a[80:81], v[144:147]
    ds_read_b64_tr_b16 a[174:175], v227 offset:41472
    v_mfma_f32_4x4x4_16b_bf16 v[148:151], a[82:83], a[82:83], v[148:151]
    v_mfma_f32_16x16x32_bf16 v[156:159], v[192:195], a[144:147], v[156:159]
    v_mfma_f32_16x16x32_bf16 v[160:163], v[192:195], a[148:151], v[160:163]
    v_mfma_f32_32x32x16_bf16 v[48:63], a[148:151], a[80:83], v[48:63]
    buffer_load_dwordx4 v214, s[12:15], s52 offen lds
    s_add_u32 m0, s53, 5120
    s_cmp_eq_u32 s58, 6
    s_cselect_b32 s57, -1032192, s59
    s_add_u32 s52, s52, s57
    s_waitcnt lgkmcnt(10)
    v_mfma_f32_32x32x16_bf16 v[32:47], a[152:155], a[84:87], v[32:47]
    buffer_load_dwordx4 v214, s[12:15], s52 offen lds
    v_mfma_f32_16x16x32_bf16 v[152:155], v[192:195], a[84:87], v[152:155]
    v_mfma_f32_4x4x4_16b_bf16 v[144:147], a[84:85], a[84:85], v[144:147]
    v_mfma_f32_4x4x4_16b_bf16 v[148:151], a[86:87], a[86:87], v[148:151]
    v_mfma_f32_32x32x16_bf16 v[48:63], a[156:159], a[84:87], v[48:63]
    s_add_u32 m0, s53, 6144
    s_cmp_eq_u32 s58, 5
    s_cselect_b32 s57, -1032192, s59
    s_add_u32 s52, s52, s57
    buffer_load_dwordx4 v214, s[12:15], s52 offen lds
    s_add_u32 m0, s53, 7168
    s_cmp_eq_u32 s58, 4
    s_cselect_b32 s57, -1032192, s59
    s_add_u32 s52, s52, s57
    s_waitcnt lgkmcnt(5)
    v_mfma_f32_32x32x16_bf16 v[32:47], a[160:163], a[88:91], v[32:47]
    buffer_load_dwordx4 v214, s[12:15], s52 offen lds
    v_mfma_f32_16x16x32_bf16 v[152:155], v[192:195], a[88:91], v[152:155]
    v_mfma_f32_4x4x4_16b_bf16 v[144:147], a[88:89], a[88:89], v[144:147]
    v_mfma_f32_4x4x4_16b_bf16 v[148:151], a[90:91], a[90:91], v[148:151]
    v_mfma_f32_32x32x16_bf16 v[48:63], a[164:167], a[88:91], v[48:63]
    s_add_u32 m0, s53, 8192
    s_cmp_eq_u32 s58, 3
    s_cselect_b32 s57, -1032192, s59
    s_add_u32 s52, s52, s57
    s_waitcnt lgkmcnt(0)
    v_mfma_f32_32x32x16_bf16 v[32:47], a[168:171], a[92:95], v[32:47]
    s_waitcnt vmcnt(5)
    s_barrier
    ds_read_b128 a[96:99], v216 offset:0
    ds_read_b64_tr_b16 a[112:113], v220 offset:49152
    ds_read_b64_tr_b16 a[114:115], v220 offset:49664
    ds_read_b64_tr_b16 a[116:117], v221 offset:49152
    ds_read_b64_tr_b16 a[118:119], v221 offset:49664
    v_mfma_f32_16x16x32_bf16 v[152:155], v[192:195], a[92:95], v[152:155]
    ds_read_b128 a[100:103], v217 offset:0
    v_mfma_f32_4x4x4_16b_bf16 v[144:147], a[92:93], a[92:93], v[144:147]
    ds_read_b64_tr_b16 a[120:121], v222 offset:49152
    v_mfma_f32_4x4x4_16b_bf16 v[148:151], a[94:95], a[94:95], v[148:151]
    ds_read_b64_tr_b16 a[122:123], v222 offset:49664
    v_mfma_f32_32x32x16_bf16 v[48:63], a[172:175], a[92:95], v[48:63]
    ds_read_b64_tr_b16 a[124:125], v223 offset:49152
    ds_read_b64_tr_b16 a[126:127], v223 offset:49664
    ds_read_b128 a[104:107], v218 offset:0
    ds_read_b64_tr_b16 a[128:129], v224 offset:49152
    ds_read_b64_tr_b16 a[130:131], v224 offset:49664
    s_waitcnt lgkmcnt(8)
    v_mfma_f32_32x32x16_bf16 v[32:47], a[112:115], a[96:99], v[32:47]
    ds_read_b64_tr_b16 a[132:133], v225 offset:49152
    ds_read_b64_tr_b16 a[134:135], v225 offset:49664
    ds_read_b128 a[108:111], v219 offset:0
    ds_read_b64_tr_b16 a[136:137], v226 offset:49152
    ds_read_b64_tr_b16 a[138:139], v226 offset:49664
    buffer_load_dwordx4 v214, s[12:15], s52 offen lds
    v_mfma_f32_16x16x32_bf16 v[152:155], v[192:195], a[96:99], v[152:155]
    ds_read_b64_tr_b16 a[140:141], v227 offset:49152
    v_mfma_f32_4x4x4_16b_bf16 v[144:147], a[96:97], a[96:97], v[144:147]
    ds_read_b64_tr_b16 a[142:143], v227 offset:49664
    v_mfma_f32_4x4x4_16b_bf16 v[148:151], a[98:99], a[98:99], v[148:151]
    v_mfma_f32_16x16x32_bf16 v[156:159], v[192:195], a[112:115], v[156:159]
    v_mfma_f32_16x16x32_bf16 v[160:163], v[192:195], a[116:119], v[160:163]
    v_mfma_f32_32x32x16_bf16 v[48:63], a[116:119], a[96:99], v[48:63]
    s_add_u32 m0, s53, 9216
    s_cmp_eq_u32 s58, 2
    s_cselect_b32 s57, -1032192, s59
    s_add_u32 s52, s52, s57
    buffer_load_dwordx4 v214, s[12:15], s52 offen lds
    s_add_u32 m0, s53, 10240
    s_cmp_eq_u32 s58, 1
    s_cselect_b32 s57, -1032192, s59
    s_add_u32 s52, s52, s57
    s_waitcnt lgkmcnt(10)
    v_mfma_f32_32x32x16_bf16 v[32:47], a[120:123], a[100:103], v[32:47]
    buffer_load_dwordx4 v214, s[12:15], s52 offen lds
    v_mfma_f32_16x16x32_bf16 v[152:155], v[192:195], a[100:103], v[152:155]
    v_mfma_f32_4x4x4_16b_bf16 v[144:147], a[100:101], a[100:101], v[144:147]
    v_mfma_f32_4x4x4_16b_bf16 v[148:151], a[102:103], a[102:103], v[148:151]
    v_mfma_f32_32x32x16_bf16 v[48:63], a[124:127], a[100:103], v[48:63]
    s_add_u32 m0, s53, 11264
    buffer_load_dword v250, v232, s[32:35], s55 offen sc1
    ds_write_b32 v237, v156 offset:57344
    ds_write_b32 v237, v160 offset:57600
    s_waitcnt lgkmcnt(7)
    v_mfma_f32_32x32x16_bf16 v[32:47], a[128:131], a[104:107], v[32:47]
    s_waitcnt lgkmcnt(0)
    s_barrier
    ds_read_b32 v164, v236 offset:57344
    ds_read_b32 v165, v236 offset:57856
    ds_read_b32 v166, v236 offset:58368
    ds_read_b32 v167, v236 offset:58880
    ds_read_b32 v168, v236 offset:57600
    buffer_load_dword v250, v215, s[40:43], 0 offen offset:0
    v_mfma_f32_16x16x32_bf16 v[152:155], v[192:195], a[104:107], v[152:155]
    ds_read_b32 v169, v236 offset:58112
    v_mfma_f32_4x4x4_16b_bf16 v[144:147], a[104:105], a[104:105], v[144:147]
    ds_read_b32 v170, v236 offset:58624
    v_mfma_f32_4x4x4_16b_bf16 v[148:151], a[106:107], a[106:107], v[148:151]
    ds_read_b32 v171, v236 offset:59136
    v_mfma_f32_32x32x16_bf16 v[48:63], a[132:135], a[104:107], v[48:63]
    s_waitcnt lgkmcnt(10)
    v_mfma_f32_16x16x32_bf16 v[152:155], v[192:195], a[108:111], v[152:155]
    v_mfma_f32_4x4x4_16b_bf16 v[144:147], a[108:109], a[108:109], v[144:147]
    v_mfma_f32_4x4x4_16b_bf16 v[148:151], a[110:111], a[110:111], v[148:151]
    v_mfma_f32_32x32x16_bf16 v[32:47], a[136:139], a[108:111], v[32:47]
    s_waitcnt lgkmcnt(0)
    v_add_f32 v164, v164, v165
    v_add_f32 v166, v166, v167
    v_add_f32 v164, v164, v166
    v_cvt_pk_bf16_f32 v165, v164, v164
    v_and_b32 v166, 0xffff0000, v165
    v_sub_f32 v164, v164, v166
    v_cvt_pk_bf16_f32 v164, v164, v164
    v_cndmask_b32 v196, v165, v164, s[46:47]
    v_mfma_f32_32x32x16_bf16 v[48:63], a[140:143], a[108:111], v[48:63]
    v_add_f32 v168, v168, v169
    v_add_f32 v170, v170, v171
    v_add_f32 v168, v168, v170
    v_cvt_pk_bf16_f32 v169, v168, v168
    v_and_b32 v170, 0xffff0000, v169
    v_sub_f32 v168, v168, v170
    v_cvt_pk_bf16_f32 v168, v168, v168
    v_cndmask_b32 v198, v169, v168, s[46:47]
    s_mov_b32 s50, 0x22222222
    s_mov_b32 s51, 0x22222222
    s_mov_b32 s58, 0x44444444
    s_mov_b32 s59, 0x44444444
    s_mov_b32 s4, 0x88888888
    s_mov_b32 s5, 0x88888888
    v_mul_f32 v238, 0xbb124925, v152
    v_cvt_pk_bf16_f32 v4, v238, v238
    v_and_b32 v4, 0xffff0000, v4
    v_sub_f32 v4, v238, v4
    v_cvt_pk_bf16_f32 v204, v238, v4
    v_add_f32 v144, v144, v148
    v_add_f32 v145, v145, v149
    v_mfma_f32_32x32x16_bf16 v[32:47], v[196:199], v[204:207], v[32:47]
    v_add_f32 v146, v146, v150
    v_add_f32 v147, v147, v151
    v_cndmask_b32 v144, v144, v145, s[50:51]
    v_cndmask_b32 v144, v144, v146, s[58:59]
    v_cndmask_b32 v144, v144, v147, s[4:5]
    v_mov_b32 v4, v144
    v_mfma_f32_32x32x16_bf16 v[48:63], v[198:201], v[204:207], v[48:63]
    v_mul_f32 v5, v238, v238
    v_permlane32_swap_b32 v4, v144
    v_add_f32 v4, v4, v144
    v_mov_b32 v6, 0x3b124925
    v_fma_f32 v4, v4, v6, -v5
    v_max_f32 v4, 0, v4
    v_add_f32 v4, 0x3727c5ac, v4
    v_rsq_f32 v4, v4
    v_and_b32 v7, 31, v1
    v_lshlrev_b32 v6, 6, v7
    v_lshrrev_b32 v7, 5, v1
    v_lshl_add_u32 v6, v7, 4, v6
    v_add_u32 v6, s53, v6
    v_mul_f32 v235, 0x3e8b97f6, v4
    v_pk_mul_f32 v[32:33], v[32:33], v[4:5] op_sel_hi:[1,0]
    v_pk_mul_f32 v[34:35], v[34:35], v[4:5] op_sel_hi:[1,0]
    v_pk_mul_f32 v[36:37], v[36:37], v[4:5] op_sel_hi:[1,0]
    v_pk_mul_f32 v[38:39], v[38:39], v[4:5] op_sel_hi:[1,0]
    v_pk_mul_f32 v[40:41], v[40:41], v[4:5] op_sel_hi:[1,0]
    v_pk_mul_f32 v[42:43], v[42:43], v[4:5] op_sel_hi:[1,0]
    v_pk_mul_f32 v[44:45], v[44:45], v[4:5] op_sel_hi:[1,0]
    v_pk_mul_f32 v[46:47], v[46:47], v[4:5] op_sel_hi:[1,0]
    v_cndmask_b32 v44, v44, 1.0, s[46:47]
    v_cndmask_b32 v45, v45, 1.0, s[46:47]
    v_cndmask_b32 v46, v46, 0, s[46:47]
    v_cndmask_b32 v47, v47, 0, s[46:47]
    v_cvt_pk_bf16_f32 v176, v32, v36
    v_cvt_pk_bf16_f32 v177, v40, v44
    v_cvt_pk_bf16_f32 v178, v33, v37
    v_cvt_pk_bf16_f32 v179, v41, v45
    v_cvt_pk_bf16_f32 v180, v34, v38
    v_cvt_pk_bf16_f32 v181, v42, v46
    v_cvt_pk_bf16_f32 v182, v35, v39
    v_cvt_pk_bf16_f32 v183, v43, v47
    v_pk_mul_f32 v[48:49], v[48:49], v[4:5] op_sel_hi:[1,0]
    v_pk_mul_f32 v[50:51], v[50:51], v[4:5] op_sel_hi:[1,0]
    v_pk_mul_f32 v[52:53], v[52:53], v[4:5] op_sel_hi:[1,0]
    v_pk_mul_f32 v[54:55], v[54:55], v[4:5] op_sel_hi:[1,0]
    v_pk_mul_f32 v[56:57], v[56:57], v[4:5] op_sel_hi:[1,0]
    v_pk_mul_f32 v[58:59], v[58:59], v[4:5] op_sel_hi:[1,0]
    v_pk_mul_f32 v[60:61], v[60:61], v[4:5] op_sel_hi:[1,0]
    v_pk_mul_f32 v[62:63], v[62:63], v[4:5] op_sel_hi:[1,0]
    v_cndmask_b32 v60, v60, 1.0, s[46:47]
    v_cndmask_b32 v61, v61, 1.0, s[46:47]
    v_cndmask_b32 v62, v62, 0, s[46:47]
    v_cndmask_b32 v63, v63, 0, s[46:47]
    v_cvt_pk_bf16_f32 v184, v48, v52
    v_cvt_pk_bf16_f32 v185, v56, v60
    v_cvt_pk_bf16_f32 v186, v49, v53
    v_cvt_pk_bf16_f32 v187, v57, v61
    v_cvt_pk_bf16_f32 v188, v50, v54
    v_cvt_pk_bf16_f32 v189, v58, v62
    v_cvt_pk_bf16_f32 v190, v51, v55
    v_cvt_pk_bf16_f32 v191, v59, v63
    s_cmp_eq_u32 s48, 0
    s_cbranch_scc1 sequential_preLN__softmax_full_mha__glu_gated_glu__prompt_kernel_notr
    ds_write_b128 v6, v[176:179] offset:12288
    ds_write_b128 v6, v[180:183] offset:12320
    ds_write_b128 v6, v[184:187] offset:14336
    ds_write_b128 v6, v[188:191] offset:14368
    s_waitcnt lgkmcnt(0)
    ds_read_b64_tr_b16 v[176:177], v239 offset:12288
    ds_read_b64_tr_b16 v[178:179], v239 offset:12544
    ds_read_b64_tr_b16 v[180:181], v239 offset:13312
    ds_read_b64_tr_b16 v[182:183], v239 offset:13568
    ds_read_b64_tr_b16 v[184:185], v239 offset:14336
    ds_read_b64_tr_b16 v[186:187], v239 offset:14592
    ds_read_b64_tr_b16 v[188:189], v239 offset:15360
    ds_read_b64_tr_b16 v[190:191], v239 offset:15616
sequential_preLN__softmax_full_mha__glu_gated_glu__prompt_kernel_notr:
    s_mov_b32 s63, 64
    s_waitcnt vmcnt(9)
sequential_preLN__softmax_full_mha__glu_gated_glu__prompt_kernel_tpc:
    v_cmp_ne_u32 vcc, s61, v234
    s_cbranch_vccz sequential_preLN__softmax_full_mha__glu_gated_glu__prompt_kernel_tpd
    buffer_load_dword v234, v233, s[32:35], s56 offen offset:0 sc1
    s_sub_u32 s63, s63, 1
    s_waitcnt vmcnt(0)
    s_cbranch_scc0 sequential_preLN__softmax_full_mha__glu_gated_glu__prompt_kernel_tpc
sequential_preLN__softmax_full_mha__glu_gated_glu__prompt_kernel_tpd:
    s_mov_b32 s40, s32
    s_mov_b32 s41, s33
    s_cmp_eq_u64 vcc, 0
    s_cselect_b32 s38, 22020096, 0
    s_cselect_b32 s42, 0, 22020096
    s_add_u32 s4, s55, 262144
    s_waitcnt lgkmcnt(0)
    s_cmp_eq_u32 s38, 0
    s_cbranch_scc1 sequential_preLN__softmax_full_mha__glu_gated_glu__prompt_kernel_sb1a
    buffer_store_dwordx4 v[176:179], v2, s[36:39], s55 offen offset:0
sequential_preLN__softmax_full_mha__glu_gated_glu__prompt_kernel_sb1b:
    s_cmp_eq_u32 s38, 0
    s_cbranch_scc1 sequential_preLN__softmax_full_mha__glu_gated_glu__prompt_kernel_sb2a
    buffer_store_dwordx4 v[180:183], v2, s[36:39], s55 offen offset:1024
sequential_preLN__softmax_full_mha__glu_gated_glu__prompt_kernel_sb2b:
    s_cmp_eq_u32 s38, 0
    s_cbranch_scc1 sequential_preLN__softmax_full_mha__glu_gated_glu__prompt_kernel_sb3a
    buffer_store_dwordx4 v[184:187], v2, s[36:39], s4 offen offset:0
sequential_preLN__softmax_full_mha__glu_gated_glu__prompt_kernel_sb3b:
    s_cmp_eq_u32 s38, 0
    s_cbranch_scc1 sequential_preLN__softmax_full_mha__glu_gated_glu__prompt_kernel_sb4a
    buffer_store_dwordx4 v[188:191], v2, s[36:39], s4 offen offset:1024
sequential_preLN__softmax_full_mha__glu_gated_glu__prompt_kernel_sb4b:
    s_waitcnt vmcnt(9)
    s_barrier
    ds_read_b64_tr_b16 a[112:113], v228 offset:0
    ds_read_b64_tr_b16 a[114:115], v228 offset:256
    ds_read_b64_tr_b16 a[116:117], v229 offset:0
    ds_read_b64_tr_b16 a[118:119], v229 offset:256
    ds_read_b64_tr_b16 a[120:121], v230 offset:0
    ds_read_b64_tr_b16 a[122:123], v230 offset:256
    ds_read_b64_tr_b16 a[124:125], v231 offset:0
    ds_read_b64_tr_b16 a[126:127], v231 offset:256
    s_lshl_b32 s4, s7, 4
    s_lshl_b32 s5, s3, 2
    s_add_u32 s4, s4, s5
    s_add_u32 s4, s4, s45
    s_add_u32 s4, s4, 819328
    s_lshl_b32 s5, s3, 7
    s_add_u32 s5, s5, s45
    s_add_u32 s5, s5, 819328
    s_waitcnt lgkmcnt(6)
    v_mfma_f32_32x32x16_bf16 v[64:79], a[112:115], a[0:3], 0
    ds_read_b64_tr_b16 a[128:129], v228 offset:1024
    ds_read_b64_tr_b16 a[130:131], v228 offset:1280
    v_mfma_f32_16x16x32_bf16 v[240:243], v[192:195], a[112:115], 0
    s_waitcnt lgkmcnt(6)
    v_mfma_f32_32x32x16_bf16 v[64:79], a[116:119], a[4:7], v[64:79]
    ds_read_b64_tr_b16 a[132:133], v229 offset:1024
    ds_read_b64_tr_b16 a[134:135], v229 offset:1280
    s_waitcnt lgkmcnt(6)
    v_mfma_f32_32x32x16_bf16 v[64:79], a[120:123], a[8:11], v[64:79]
    ds_read_b64_tr_b16 a[136:137], v230 offset:1024
    ds_read_b64_tr_b16 a[138:139], v230 offset:1280
    s_waitcnt lgkmcnt(6)
    v_mfma_f32_32x32x16_bf16 v[64:79], a[124:127], a[12:15], v[64:79]
    ds_read_b64_tr_b16 a[140:141], v231 offset:1024
    ds_read_b64_tr_b16 a[142:143], v231 offset:1280
    s_waitcnt lgkmcnt(6)
    v_mfma_f32_32x32x16_bf16 v[64:79], a[128:131], a[16:19], v[64:79]
    ds_read_b64_tr_b16 a[144:145], v228 offset:2048
    ds_read_b64_tr_b16 a[146:147], v228 offset:2304
    v_mfma_f32_16x16x32_bf16 v[240:243], v[192:195], a[128:131], v[240:243]
    s_waitcnt lgkmcnt(6)
    v_mfma_f32_32x32x16_bf16 v[64:79], a[132:135], a[20:23], v[64:79]
    ds_read_b64_tr_b16 a[148:149], v229 offset:2048
    ds_read_b64_tr_b16 a[150:151], v229 offset:2304
    s_waitcnt lgkmcnt(6)
    v_mfma_f32_32x32x16_bf16 v[64:79], a[136:139], a[24:27], v[64:79]
    ds_read_b64_tr_b16 a[152:153], v230 offset:2048
    ds_read_b64_tr_b16 a[154:155], v230 offset:2304
    s_waitcnt lgkmcnt(6)
    v_mfma_f32_32x32x16_bf16 v[64:79], a[140:143], a[28:31], v[64:79]
    ds_read_b64_tr_b16 a[156:157], v231 offset:2048
    ds_read_b64_tr_b16 a[158:159], v231 offset:2304
    s_waitcnt lgkmcnt(6)
    v_mfma_f32_32x32x16_bf16 v[64:79], a[144:147], a[32:35], v[64:79]
    ds_read_b64_tr_b16 a[160:161], v228 offset:3072
    ds_read_b64_tr_b16 a[162:163], v228 offset:3328
    v_mfma_f32_16x16x32_bf16 v[240:243], v[192:195], a[144:147], v[240:243]
    s_waitcnt lgkmcnt(6)
    v_mfma_f32_32x32x16_bf16 v[64:79], a[148:151], a[36:39], v[64:79]
    ds_read_b64_tr_b16 a[164:165], v229 offset:3072
    ds_read_b64_tr_b16 a[166:167], v229 offset:3328
    s_waitcnt lgkmcnt(6)
    v_mfma_f32_32x32x16_bf16 v[64:79], a[152:155], a[40:43], v[64:79]
    ds_read_b64_tr_b16 a[168:169], v230 offset:3072
    ds_read_b64_tr_b16 a[170:171], v230 offset:3328
    s_waitcnt lgkmcnt(6)
    v_mfma_f32_32x32x16_bf16 v[64:79], a[156:159], a[44:47], v[64:79]
    ds_read_b64_tr_b16 a[172:173], v231 offset:3072
    ds_read_b64_tr_b16 a[174:175], v231 offset:3328
    s_waitcnt lgkmcnt(6)
    v_mfma_f32_32x32x16_bf16 v[64:79], a[160:163], a[48:51], v[64:79]
    s_waitcnt vmcnt(6)
    s_barrier
    ds_read_b64_tr_b16 a[112:113], v228 offset:4096
    ds_read_b64_tr_b16 a[114:115], v228 offset:4352
    v_mfma_f32_16x16x32_bf16 v[240:243], v[192:195], a[160:163], v[240:243]
    s_waitcnt vmcnt(0)
    s_cmp_eq_u32 s38, 0
    s_cbranch_scc1 sequential_preLN__softmax_full_mha__glu_gated_glu__prompt_kernel_sb5a
    buffer_store_dword v30, v31, s[36:39], s4 offen offset:0
sequential_preLN__softmax_full_mha__glu_gated_glu__prompt_kernel_sb5b:
    s_waitcnt lgkmcnt(6)
    v_mfma_f32_32x32x16_bf16 v[64:79], a[164:167], a[52:55], v[64:79]
    ds_read_b64_tr_b16 a[116:117], v229 offset:4096
    ds_read_b64_tr_b16 a[118:119], v229 offset:4352
    s_waitcnt lgkmcnt(6)
    v_mfma_f32_32x32x16_bf16 v[64:79], a[168:171], a[56:59], v[64:79]
    ds_read_b64_tr_b16 a[120:121], v230 offset:4096
    ds_read_b64_tr_b16 a[122:123], v230 offset:4352
    s_waitcnt lgkmcnt(6)
    v_mfma_f32_32x32x16_bf16 v[64:79], a[172:175], a[60:63], v[64:79]
    ds_read_b64_tr_b16 a[124:125], v231 offset:4096
    ds_read_b64_tr_b16 a[126:127], v231 offset:4352
    s_waitcnt lgkmcnt(6)
    v_mfma_f32_32x32x16_bf16 v[64:79], a[112:115], a[64:67], v[64:79]
    ds_read_b64_tr_b16 a[128:129], v228 offset:5120
    ds_read_b64_tr_b16 a[130:131], v228 offset:5376
    v_mfma_f32_16x16x32_bf16 v[240:243], v[192:195], a[112:115], v[240:243]
    s_waitcnt lgkmcnt(6)
    v_mfma_f32_32x32x16_bf16 v[64:79], a[116:119], a[68:71], v[64:79]
    ds_read_b64_tr_b16 a[132:133], v229 offset:5120
    ds_read_b64_tr_b16 a[134:135], v229 offset:5376
    s_waitcnt lgkmcnt(6)
    v_mfma_f32_32x32x16_bf16 v[64:79], a[120:123], a[72:75], v[64:79]
    ds_read_b64_tr_b16 a[136:137], v230 offset:5120
    ds_read_b64_tr_b16 a[138:139], v230 offset:5376
    s_waitcnt lgkmcnt(6)
    v_mfma_f32_32x32x16_bf16 v[64:79], a[124:127], a[76:79], v[64:79]
    ds_read_b64_tr_b16 a[140:141], v231 offset:5120
    ds_read_b64_tr_b16 a[142:143], v231 offset:5376
    s_waitcnt lgkmcnt(6)
    v_mfma_f32_32x32x16_bf16 v[64:79], a[128:131], a[80:83], v[64:79]
    ds_read_b64_tr_b16 a[144:145], v228 offset:6144
    ds_read_b64_tr_b16 a[146:147], v228 offset:6400
    v_mfma_f32_16x16x32_bf16 v[240:243], v[192:195], a[128:131], v[240:243]
    s_waitcnt lgkmcnt(6)
    v_mfma_f32_32x32x16_bf16 v[64:79], a[132:135], a[84:87], v[64:79]
    ds_read_b64_tr_b16 a[148:149], v229 offset:6144
    ds_read_b64_tr_b16 a[150:151], v229 offset:6400
    s_waitcnt lgkmcnt(6)
    v_mfma_f32_32x32x16_bf16 v[64:79], a[136:139], a[88:91], v[64:79]
    ds_read_b64_tr_b16 a[152:153], v230 offset:6144
    ds_read_b64_tr_b16 a[154:155], v230 offset:6400
    s_waitcnt lgkmcnt(6)
    v_mfma_f32_32x32x16_bf16 v[64:79], a[140:143], a[92:95], v[64:79]
    ds_read_b64_tr_b16 a[156:157], v231 offset:6144
    ds_read_b64_tr_b16 a[158:159], v231 offset:6400
    s_waitcnt lgkmcnt(6)
    v_mfma_f32_32x32x16_bf16 v[64:79], a[144:147], a[96:99], v[64:79]
    v_mfma_f32_16x16x32_bf16 v[240:243], v[192:195], a[144:147], v[240:243]
    s_waitcnt lgkmcnt(4)
    v_mfma_f32_32x32x16_bf16 v[64:79], a[148:151], a[100:103], v[64:79]
    s_nop 5
    ds_write_b32 v237, v240
    s_waitcnt lgkmcnt(3)
    v_mfma_f32_32x32x16_bf16 v[64:79], a[152:155], a[104:107], v[64:79]
    s_waitcnt lgkmcnt(0)
    s_barrier
    ds_read_b32 v244, v236 offset:0
    ds_read_b32 v245, v236 offset:512
    ds_read_b32 v246, v236 offset:1024
    ds_read_b32 v247, v236 offset:1536
    buffer_load_dword v234, v233, s[32:35], s5 offen offset:0 sc1
    s_waitcnt lgkmcnt(5)
    v_mfma_f32_32x32x16_bf16 v[64:79], a[156:159], a[108:111], v[64:79]
    s_waitcnt lgkmcnt(0)
    v_add_f32 v244, v244, v245
    v_add_f32 v246, v246, v247
    v_add_f32 v244, v244, v246
    v_cvt_pk_bf16_f32 v245, v244, v244
    v_and_b32 v246, 0xffff0000, v245
    v_sub_f32 v244, v244, v246
    v_cvt_pk_bf16_f32 v244, v244, v244
    v_cndmask_b32 v200, v245, v244, s[46:47]
    v_mov_b32 v4, v235
    s_nop 0
    v_mfma_f32_32x32x16_bf16 v[64:79], v[200:203], v[204:207], v[64:79]
    s_lshl_b32 s4, s3, 11
    s_add_u32 s4, s4, 57344
    v_add_u32 v6, s4, v2
    s_nop 8
    v_pk_mul_f32 v[64:65], v[64:65], v[4:5] op_sel_hi:[1,0]
    v_pk_mul_f32 v[66:67], v[66:67], v[4:5] op_sel_hi:[1,0]
    v_pk_mul_f32 v[68:69], v[68:69], v[4:5] op_sel_hi:[1,0]
    v_pk_mul_f32 v[70:71], v[70:71], v[4:5] op_sel_hi:[1,0]
    v_pk_mul_f32 v[72:73], v[72:73], v[4:5] op_sel_hi:[1,0]
    v_pk_mul_f32 v[74:75], v[74:75], v[4:5] op_sel_hi:[1,0]
    v_pk_mul_f32 v[76:77], v[76:77], v[4:5] op_sel_hi:[1,0]
    v_pk_mul_f32 v[78:79], v[78:79], v[4:5] op_sel_hi:[1,0]
    v_cndmask_b32 v76, v76, 0, s[46:47]
    v_cndmask_b32 v77, v77, 0, s[46:47]
    v_cndmask_b32 v78, v78, 0, s[46:47]
    v_cndmask_b32 v79, v79, 0, s[46:47]
    v_cvt_pk_bf16_f32 v176, v64, v68
    v_cvt_pk_bf16_f32 v177, v72, v76
    v_cvt_pk_bf16_f32 v178, v65, v69
    v_cvt_pk_bf16_f32 v179, v73, v77
    v_cvt_pk_bf16_f32 v180, v66, v70
    v_cvt_pk_bf16_f32 v181, v74, v78
    v_cvt_pk_bf16_f32 v182, v67, v71
    v_cvt_pk_bf16_f32 v183, v75, v79
    ds_write_b128 v6, v[176:179] offset:0
    ds_write_b128 v6, v[180:183] offset:1024
    s_mov_b32 s63, 65536
    s_waitcnt vmcnt(0)
sequential_preLN__softmax_full_mha__glu_gated_glu__prompt_kernel_fac:
    v_cmp_ne_u32 vcc, s44, v234
    s_cbranch_vccz sequential_preLN__softmax_full_mha__glu_gated_glu__prompt_kernel_fad
    buffer_load_dword v234, v233, s[32:35], s5 offen offset:0 sc1
    s_sub_u32 s63, s63, 1
    s_waitcnt vmcnt(0)
    s_cbranch_scc0 sequential_preLN__softmax_full_mha__glu_gated_glu__prompt_kernel_fac
sequential_preLN__softmax_full_mha__glu_gated_glu__prompt_kernel_fad:
    s_lshl_b32 s56, s48, 18
    s_add_u32 s56, s56, s45
    s_lshl_b32 s50, s3, 16
    s_add_u32 s50, s50, s56
    buffer_load_dwordx4 v[144:147], v2, s[32:35], s50 offen offset:0 sc1
    buffer_load_dwordx4 v[148:151], v2, s[32:35], s50 offen offset:1024 sc1
    buffer_load_dwordx4 v[152:155], v2, s[32:35], s50 offen offset:2048 sc1
    buffer_load_dwordx4 v[156:159], v2, s[32:35], s50 offen offset:3072 sc1
    s_add_u32 s50, s50, 4096
    buffer_load_dwordx4 v[160:163], v2, s[32:35], s50 offen offset:0 sc1
    buffer_load_dwordx4 v[164:167], v2, s[32:35], s50 offen offset:1024 sc1
    buffer_load_dwordx4 v[168:171], v2, s[32:35], s50 offen offset:2048 sc1
    buffer_load_dwordx4 v[172:175], v2, s[32:35], s50 offen offset:3072 sc1
    s_add_u32 s50, s50, 4096
    s_waitcnt lgkmcnt(0)
    s_barrier
    v_xor_b32 v6, 6144, v6
    ds_read_b128 a[224:227], v6 offset:0
    ds_read_b128 a[228:231], v6 offset:1024
    v_xor_b32 v7, 2048, v6
    ds_read_b128 a[232:235], v7 offset:0
    ds_read_b128 a[236:239], v7 offset:1024
    v_xor_b32 v7, 4096, v6
sequential_preLN__softmax_full_mha__glu_gated_glu__prompt_kernel_pg2:
    s_cbranch_execz sequential_preLN__softmax_full_mha__glu_gated_glu__prompt_kernel_tb1
    ds_read_b128 a[240:243], v7 offset:0
    ds_read_b128 a[244:247], v7 offset:1024
    v_xor_b32 v7, 6144, v6
    ds_read_b128 a[248:251], v7 offset:0
    ds_read_b128 a[252:255], v7 offset:1024
    s_lshl_b32 s51, s49, 8
    s_lshr_b32 s4, s3, 1
    s_lshl_b32 s4, s4, 7
    s_add_u32 s51, s51, s4
    s_lshr_b32 s4, s49, 1
    s_lshl_b32 s4, s4, 7
    s_mul_i32 s52, s3, 100352
    s_add_u32 s52, s52, s4
    s_lshl_b32 s53, s3, 12
    s_add_u32 s53, s53, 65536
    s_mul_i32 s54, s3, 14336
    s_lshl_b32 s55, s6, 4
    s_lshl_b32 s5, s48, 3
    s_add_u32 s55, s55, s5
    s_and_b32 s5, s49, 1
    s_add_u32 s55, s55, s5
    s_and_b32 s5, s3, 2
    s_add_u32 s57, s55, s5
    s_mul_i32 s55, s57, 14336
    s_add_u32 s55, s55, s4
    s_and_b32 s5, s3, 1
    s_lshl_b32 s5, s5, 6
    s_add_u32 s55, s55, s5
    s_waitcnt vmcnt(6) lgkmcnt(6)
    v_mfma_f32_32x32x16_bf16 v[32:47], v[144:147], a[224:227], 0
    v_mfma_f32_32x32x16_bf16 v[32:47], v[148:151], a[228:231], v[32:47]
    s_waitcnt lgkmcnt(4)
    v_mfma_f32_32x32x16_bf16 v[48:63], v[144:147], a[232:235], 0
    s_add_u32 m0, s53, 16384
    s_nop 8
    v_exp_f32 v32, v32
    v_exp_f32 v33, v33
    v_exp_f32 v34, v34
    v_mfma_f32_32x32x16_bf16 v[48:63], v[148:151], a[236:239], v[48:63]
    buffer_load_dwordx4 v[176:179], v2, s[32:35], s50 offen offset:0 sc1
    v_exp_f32 v35, v35
    v_exp_f32 v36, v36
    v_exp_f32 v37, v37
    s_waitcnt vmcnt(5)
    v_exp_f32 v38, v38
    v_exp_f32 v39, v39
    v_exp_f32 v40, v40
    v_exp_f32 v41, v41
    v_smfmac_f32_32x32x32_bf16 v[80:95], v[152:155], v[32:39], v3
    s_waitcnt lgkmcnt(2)
    buffer_load_dwordx4 v[180:183], v2, s[32:35], s50 offen offset:1024 sc1
    v_exp_f32 v42, v42
    v_exp_f32 v43, v43
    v_exp_f32 v44, v44
    v_exp_f32 v45, v45
    v_exp_f32 v46, v46
    v_exp_f32 v47, v47
    v_mfma_f32_32x32x16_bf16 v[64:79], v[144:147], a[240:243], 0
    v_exp_f32 v48, v48
    v_exp_f32 v49, v49
    v_exp_f32 v50, v50
    v_mfma_f32_32x32x16_bf16 v[64:79], v[148:151], a[244:247], v[64:79]
    buffer_load_dwordx4 v[184:187], v2, s[32:35], s50 offen offset:2048 sc1
    v_exp_f32 v51, v51
    v_exp_f32 v52, v52
    v_exp_f32 v53, v53
    v_smfmac_f32_32x32x32_bf16 v[80:95], v[156:159], v[40:47], v3
    v_exp_f32 v54, v54
    v_exp_f32 v55, v55
    v_exp_f32 v56, v56
    v_exp_f32 v57, v57
    v_smfmac_f32_32x32x32_bf16 v[96:111], v[152:155], v[48:55], v3
    s_waitcnt lgkmcnt(0)
    buffer_load_dwordx4 v[188:191], v2, s[32:35], s50 offen offset:3072 sc1
    s_add_u32 s50, s50, 4096
    v_exp_f32 v58, v58
    v_exp_f32 v59, v59
    v_exp_f32 v60, v60
    v_exp_f32 v61, v61
    v_exp_f32 v62, v62
    v_exp_f32 v63, v63
    v_mfma_f32_32x32x16_bf16 v[32:47], v[144:147], a[248:251], 0
    s_and_b32 s59, s57, 3
    v_exp_f32 v64, v64
    v_exp_f32 v65, v65
    v_exp_f32 v66, v66
    v_mfma_f32_32x32x16_bf16 v[32:47], v[148:151], a[252:255], v[32:47]
    s_add_u32 s58, s57, s59
    buffer_load_dwordx4 v[192:195], v2, s[32:35], s50 offen offset:0 sc1
    v_exp_f32 v67, v67
    v_exp_f32 v68, v68
    v_exp_f32 v69, v69
    v_smfmac_f32_32x32x32_bf16 v[96:111], v[156:159], v[56:63], v3
    s_lshl_b32 s58, s58, 10
    buffer_load_dwordx4 v[196:199], v2, s[32:35], s50 offen offset:1024 sc1
    v_exp_f32 v70, v70
    v_exp_f32 v71, v71
    v_exp_f32 v72, v72
    v_exp_f32 v73, v73
    v_smfmac_f32_32x32x32_bf16 v[112:127], v[152:155], v[64:71], v3
    s_waitcnt vmcnt(6)
    v_exp_f32 v74, v74
    v_exp_f32 v75, v75
    v_exp_f32 v76, v76
    v_exp_f32 v77, v77
    v_exp_f32 v78, v78
    v_exp_f32 v79, v79
    v_mfma_f32_32x32x16_bf16 v[48:63], v[160:163], a[224:227], 0
    s_and_b32 s59, s3, 1
    buffer_load_dwordx4 v[200:203], v2, s[32:35], s50 offen offset:2048 sc1
    v_exp_f32 v32, v32
    v_exp_f32 v33, v33
    v_exp_f32 v34, v34
    v_mfma_f32_32x32x16_bf16 v[48:63], v[164:167], a[228:231], v[48:63]
    s_lshl_b32 s59, s59, 20
    v_exp_f32 v35, v35
    v_exp_f32 v36, v36
    v_exp_f32 v37, v37
    v_smfmac_f32_32x32x32_bf16 v[112:127], v[156:159], v[72:79], v3
    s_add_u32 s58, s58, s59
    buffer_load_dwordx4 v[204:207], v2, s[32:35], s50 offen offset:3072 sc1
    s_add_u32 s50, s50, 4096
    v_exp_f32 v38, v38
    v_exp_f32 v39, v39
    v_exp_f32 v40, v40
    v_exp_f32 v41, v41
    v_smfmac_f32_32x32x32_bf16 v[128:143], v[152:155], v[32:39], v3
    s_add_u32 s58, s58, 16777216
    v_exp_f32 v42, v42
    v_exp_f32 v43, v43
    v_exp_f32 v44, v44
    v_exp_f32 v45, v45
    v_exp_f32 v46, v46
    v_exp_f32 v47, v47
    v_mfma_f32_32x32x16_bf16 v[64:79], v[160:163], a[232:235], 0
    s_add_u32 s59, s6, 1
    buffer_load_dwordx4 v[208:211], v2, s[32:35], s50 offen offset:0 sc1
    v_exp_f32 v48, v48
    v_exp_f32 v49, v49
    v_exp_f32 v50, v50
    v_mfma_f32_32x32x16_bf16 v[64:79], v[164:167], a[236:239], v[64:79]
    s_and_b32 s59, s59, 3
    v_exp_f32 v51, v51
    v_exp_f32 v52, v52
    v_exp_f32 v53, v53
    v_smfmac_f32_32x32x32_bf16 v[128:143], v[156:159], v[40:47], v3
    s_lshl_b32 s59, s59, 18
    buffer_load_dwordx4 v[212:215], v2, s[32:35], s50 offen offset:1024 sc1
    v_exp_f32 v54, v54
    v_exp_f32 v55, v55
    v_exp_f32 v56, v56
    v_exp_f32 v57, v57
    v_smfmac_f32_32x32x32_bf16 v[80:95], v[168:171], v[48:55], v3
    s_add_u32 s12, s58, s59
    buffer_load_dwordx4 v[216:219], v2, s[32:35], s50 offen offset:2048 sc1
    v_exp_f32 v58, v58
    v_exp_f32 v59, v59
    v_exp_f32 v60, v60
    v_exp_f32 v61, v61
    v_exp_f32 v62, v62
    v_exp_f32 v63, v63
    v_mfma_f32_32x32x16_bf16 v[32:47], v[160:163], a[240:243], 0
    s_add_u32 s59, s6, 2
    v_exp_f32 v64, v64
    v_exp_f32 v65, v65
    v_exp_f32 v66, v66
    v_mfma_f32_32x32x16_bf16 v[32:47], v[164:167], a[244:247], v[32:47]
    s_and_b32 s59, s59, 3
    buffer_load_dwordx4 v[220:223], v2, s[32:35], s50 offen offset:3072 sc1
    s_add_u32 s50, s50, 4096
    v_exp_f32 v67, v67
    v_exp_f32 v68, v68
    v_exp_f32 v69, v69
    v_smfmac_f32_32x32x32_bf16 v[80:95], v[172:175], v[56:63], v3
    s_lshl_b32 s59, s59, 18
    v_exp_f32 v70, v70
    v_exp_f32 v71, v71
    v_exp_f32 v72, v72
    v_exp_f32 v73, v73
    v_smfmac_f32_32x32x32_bf16 v[96:111], v[168:171], v[64:71], v3
    s_add_u32 s13, s58, s59
    buffer_load_dwordx4 v[224:227], v2, s[32:35], s50 offen offset:0 sc1
    v_exp_f32 v74, v74
    v_exp_f32 v75, v75
    v_exp_f32 v76, v76
    v_exp_f32 v77, v77
    v_exp_f32 v78, v78
    v_exp_f32 v79, v79
    v_mfma_f32_32x32x16_bf16 v[48:63], v[160:163], a[248:251], 0
    s_add_u32 s59, s6, 3
    v_exp_f32 v32, v32
    v_exp_f32 v33, v33
    v_exp_f32 v34, v34
    v_mfma_f32_32x32x16_bf16 v[48:63], v[164:167], a[252:255], v[48:63]
    s_and_b32 s59, s59, 3
    buffer_load_dwordx4 v[228:231], v2, s[32:35], s50 offen offset:1024 sc1
    v_exp_f32 v35, v35
    v_exp_f32 v36, v36
    v_exp_f32 v37, v37
    v_smfmac_f32_32x32x32_bf16 v[96:111], v[172:175], v[72:79], v3
    s_lshl_b32 s59, s59, 18
    v_exp_f32 v38, v38
    v_exp_f32 v39, v39
    v_exp_f32 v40, v40
    v_exp_f32 v41, v41
    v_smfmac_f32_32x32x32_bf16 v[112:127], v[168:171], v[32:39], v3
    s_waitcnt vmcnt(10)
    buffer_load_dwordx4 v[232:235], v2, s[32:35], s50 offen offset:2048 sc1
    v_exp_f32 v42, v42
    v_exp_f32 v43, v43
    v_exp_f32 v44, v44
    v_exp_f32 v45, v45
    v_exp_f32 v46, v46
    v_exp_f32 v47, v47
    v_mfma_f32_32x32x16_bf16 v[64:79], v[176:179], a[224:227], 0
    s_add_u32 s14, s58, s59
    v_exp_f32 v48, v48
    v_exp_f32 v49, v49
    v_exp_f32 v50, v50
    v_mfma_f32_32x32x16_bf16 v[64:79], v[180:183], a[228:231], v[64:79]
    s_add_u32 s59, s6, 4
    buffer_load_dwordx4 v[236:239], v2, s[32:35], s50 offen offset:3072 sc1
    s_add_u32 s50, s50, 4096
    v_exp_f32 v51, v51
    v_exp_f32 v52, v52
    v_exp_f32 v53, v53
    v_smfmac_f32_32x32x32_bf16 v[112:127], v[172:175], v[40:47], v3
    s_and_b32 s59, s59, 3
    buffer_load_dwordx4 v[144:147], v2, s[32:35], s50 offen offset:0 sc1
    v_exp_f32 v54, v54
    v_exp_f32 v55, v55
    v_exp_f32 v56, v56
    v_exp_f32 v57, v57
    v_smfmac_f32_32x32x32_bf16 v[128:143], v[168:171], v[48:55], v3
    s_lshl_b32 s59, s59, 18
    v_exp_f32 v58, v58
    v_exp_f32 v59, v59
    v_exp_f32 v60, v60
    v_exp_f32 v61, v61
    v_exp_f32 v62, v62
    v_exp_f32 v63, v63
    v_mfma_f32_32x32x16_bf16 v[32:47], v[176:179], a[232:235], 0
    s_add_u32 s15, s58, s59
    buffer_load_dwordx4 v[148:151], v2, s[32:35], s50 offen offset:1024 sc1
    v_exp_f32 v64, v64
    v_exp_f32 v65, v65
    v_exp_f32 v66, v66
    v_mfma_f32_32x32x16_bf16 v[32:47], v[180:183], a[236:239], v[32:47]
    s_lshl_b32 s59, s7, 2
    v_exp_f32 v67, v67
    v_exp_f32 v68, v68
    v_exp_f32 v69, v69
    v_smfmac_f32_32x32x32_bf16 v[128:143], v[172:175], v[56:63], v3
    s_add_u32 s59, s59, s45
    buffer_load_dwordx4 v[152:155], v2, s[32:35], s50 offen offset:2048 sc1
    v_exp_f32 v70, v70
    v_exp_f32 v71, v71
    v_exp_f32 v72, v72
    v_exp_f32 v73, v73
    v_smfmac_f32_32x32x32_bf16 v[80:95], v[184:187], v[64:71], v3
    s_add_u32 s60, s59, 819840
    v_exp_f32 v74, v74
    v_exp_f32 v75, v75
    v_exp_f32 v76, v76
    v_exp_f32 v77, v77
    v_exp_f32 v78, v78
    v_exp_f32 v79, v79
    v_mfma_f32_32x32x16_bf16 v[48:63], v[176:179], a[240:243], 0
    s_lshl_b32 s62, s49, 13
    buffer_load_dwordx4 v[156:159], v2, s[32:35], s50 offen offset:3072 sc1
    s_add_u32 s50, s50, 4096
    v_exp_f32 v32, v32
    v_exp_f32 v33, v33
    v_exp_f32 v34, v34
    v_mfma_f32_32x32x16_bf16 v[48:63], v[180:183], a[244:247], v[48:63]
    s_and_b32 s59, s3, 1
    v_exp_f32 v35, v35
    v_exp_f32 v36, v36
    v_exp_f32 v37, v37
    v_smfmac_f32_32x32x32_bf16 v[80:95], v[188:191], v[72:79], v3
    s_lshl_b32 s59, s59, 12
    buffer_load_dwordx4 v[160:163], v2, s[32:35], s50 offen offset:0 sc1
    v_exp_f32 v38, v38
    v_exp_f32 v39, v39
    v_exp_f32 v40, v40
    v_exp_f32 v41, v41
    v_smfmac_f32_32x32x32_bf16 v[96:111], v[184:187], v[32:39], v3
    s_add_u32 s62, s62, s59
    buffer_load_dwordx4 v[164:167], v2, s[32:35], s50 offen offset:1024 sc1
    v_exp_f32 v42, v42
    v_exp_f32 v43, v43
    v_exp_f32 v44, v44
    v_exp_f32 v45, v45
    v_exp_f32 v46, v46
    v_exp_f32 v47, v47
    v_mfma_f32_32x32x16_bf16 v[64:79], v[176:179], a[248:251], 0
    s_lshr_b32 s59, s3, 1
    v_exp_f32 v48, v48
    v_exp_f32 v49, v49
    v_exp_f32 v50, v50
    v_mfma_f32_32x32x16_bf16 v[64:79], v[180:183], a[252:255], v[64:79]
    s_lshl_b32 s59, s59, 10
    buffer_load_dwordx4 v[168:171], v2, s[32:35], s50 offen offset:2048 sc1
    v_exp_f32 v51, v51
    v_exp_f32 v52, v52
    v_exp_f32 v53, v53
    v_smfmac_f32_32x32x32_bf16 v[96:111], v[188:191], v[40:47], v3
    s_add_u32 s62, s62, s59
    v_exp_f32 v54, v54
    v_exp_f32 v55, v55
    v_exp_f32 v56, v56
    v_exp_f32 v57, v57
    v_smfmac_f32_32x32x32_bf16 v[112:127], v[184:187], v[48:55], v3
    s_waitcnt vmcnt(15)
    buffer_load_dwordx4 v[172:175], v2, s[32:35], s50 offen offset:3072 sc1
    s_add_u32 s50, s50, 4096
    v_exp_f32 v58, v58
    v_exp_f32 v59, v59
    v_exp_f32 v60, v60
    v_exp_f32 v61, v61
    v_exp_f32 v62, v62
    v_exp_f32 v63, v63
    v_mfma_f32_32x32x16_bf16 v[32:47], v[192:195], a[224:227], 0
    s_lshl_b32 s59, s6, 1
    v_exp_f32 v64, v64
    v_exp_f32 v65, v65
    v_exp_f32 v66, v66
    v_mfma_f32_32x32x16_bf16 v[32:47], v[196:199], a[228:231], v[32:47]
    s_add_u32 s59, s59, s48
    buffer_load_dwordx4 v8, s[20:23], s51 offen offset:0 lds
    v_exp_f32 v67, v67
    v_exp_f32 v68, v68
    v_exp_f32 v69, v69
    v_smfmac_f32_32x32x32_bf16 v[112:127], v[188:191], v[56:63], v3
    s_lshl_b32 s59, s59, 17
    v_exp_f32 v70, v70
    v_exp_f32 v71, v71
    v_exp_f32 v72, v72
    v_exp_f32 v73, v73
    v_smfmac_f32_32x32x32_bf16 v[128:143], v[184:187], v[64:71], v3
    s_add_u32 s62, s62, s59
    buffer_load_dwordx4 v9, s[20:23], s51 offen offset:1024 lds
    v_exp_f32 v74, v74
    v_exp_f32 v75, v75
    v_exp_f32 v76, v76
    v_exp_f32 v77, v77
    v_exp_f32 v78, v78
    v_exp_f32 v79, v79
    v_mfma_f32_32x32x16_bf16 v[48:63], v[192:195], a[232:235], 0
    s_add_u32 s62, s62, 16777216
    v_exp_f32 v32, v32
    v_exp_f32 v33, v33
    v_exp_f32 v34, v34
    v_mfma_f32_32x32x16_bf16 v[48:63], v[196:199], a[236:239], v[48:63]
    s_and_b32 s61, s44, 0xffff0000
    buffer_load_dwordx4 v10, s[20:23], s51 offen offset:2048 lds
    v_exp_f32 v35, v35
    v_exp_f32 v36, v36
    v_exp_f32 v37, v37
    v_smfmac_f32_32x32x32_bf16 v[128:143], v[188:191], v[72:79], v3
    buffer_load_dwordx4 v11, s[20:23], s51 offen offset:3072 lds
    s_add_u32 s51, s51, 114688
    v_exp_f32 v38, v38
    v_exp_f32 v39, v39
    v_exp_f32 v40, v40
    v_exp_f32 v41, v41
    v_smfmac_f32_32x32x32_bf16 v[80:95], v[200:203], v[32:39], v3
    s_add_u32 m0, s53, 32768
    v_exp_f32 v42, v42
    v_exp_f32 v43, v43
    v_exp_f32 v44, v44
    v_exp_f32 v45, v45
    v_exp_f32 v46, v46
    v_exp_f32 v47, v47
    v_mfma_f32_32x32x16_bf16 v[64:79], v[192:195], a[240:243], 0
    buffer_load_dwordx4 v[176:179], v2, s[32:35], s50 offen offset:0 sc1
    v_exp_f32 v48, v48
    v_exp_f32 v49, v49
    v_exp_f32 v50, v50
    v_mfma_f32_32x32x16_bf16 v[64:79], v[196:199], a[244:247], v[64:79]
    v_exp_f32 v51, v51
    v_exp_f32 v52, v52
    v_exp_f32 v53, v53
    v_smfmac_f32_32x32x32_bf16 v[80:95], v[204:207], v[40:47], v3
    buffer_load_dwordx4 v[180:183], v2, s[32:35], s50 offen offset:1024 sc1
    v_exp_f32 v54, v54
    v_exp_f32 v55, v55
    v_exp_f32 v56, v56
    v_exp_f32 v57, v57
    v_smfmac_f32_32x32x32_bf16 v[96:111], v[200:203], v[48:55], v3
    v_exp_f32 v58, v58
    v_exp_f32 v59, v59
    v_exp_f32 v60, v60
    v_exp_f32 v61, v61
    v_exp_f32 v62, v62
    v_exp_f32 v63, v63
    v_mfma_f32_32x32x16_bf16 v[32:47], v[192:195], a[248:251], 0
    buffer_load_dwordx4 v[184:187], v2, s[32:35], s50 offen offset:2048 sc1
    v_exp_f32 v64, v64
    v_exp_f32 v65, v65
    v_exp_f32 v66, v66
    v_mfma_f32_32x32x16_bf16 v[32:47], v[196:199], a[252:255], v[32:47]
    v_exp_f32 v67, v67
    v_exp_f32 v68, v68
    v_exp_f32 v69, v69
    v_smfmac_f32_32x32x32_bf16 v[96:111], v[204:207], v[56:63], v3
    buffer_load_dwordx4 v[188:191], v2, s[32:35], s50 offen offset:3072 sc1
    s_add_u32 s50, s50, 4096
    v_exp_f32 v70, v70
    v_exp_f32 v71, v71
    v_exp_f32 v72, v72
    v_exp_f32 v73, v73
    v_smfmac_f32_32x32x32_bf16 v[112:127], v[200:203], v[64:71], v3
    s_waitcnt vmcnt(20)
    buffer_load_dwordx4 v8, s[20:23], s51 offen offset:0 lds
    v_exp_f32 v74, v74
    v_exp_f32 v75, v75
    v_exp_f32 v76, v76
    v_exp_f32 v77, v77
    v_exp_f32 v78, v78
    v_exp_f32 v79, v79
    v_mfma_f32_32x32x16_bf16 v[48:63], v[208:211], a[224:227], 0
    v_exp_f32 v32, v32
    v_exp_f32 v33, v33
    v_exp_f32 v34, v34
    v_mfma_f32_32x32x16_bf16 v[48:63], v[212:215], a[228:231], v[48:63]
    buffer_load_dwordx4 v9, s[20:23], s51 offen offset:1024 lds
    v_exp_f32 v35, v35
    v_exp_f32 v36, v36
    v_exp_f32 v37, v37
    v_smfmac_f32_32x32x32_bf16 v[112:127], v[204:207], v[72:79], v3
    v_exp_f32 v38, v38
    v_exp_f32 v39, v39
    v_exp_f32 v40, v40
    v_exp_f32 v41, v41
    v_smfmac_f32_32x32x32_bf16 v[128:143], v[200:203], v[32:39], v3
    buffer_load_dwordx4 v10, s[20:23], s51 offen offset:2048 lds
    v_exp_f32 v42, v42
    v_exp_f32 v43, v43
    v_exp_f32 v44, v44
    v_exp_f32 v45, v45
    v_exp_f32 v46, v46
    v_exp_f32 v47, v47
    v_mfma_f32_32x32x16_bf16 v[64:79], v[208:211], a[232:235], 0
    v_exp_f32 v48, v48
    v_exp_f32 v49, v49
    v_exp_f32 v50, v50
    v_mfma_f32_32x32x16_bf16 v[64:79], v[212:215], a[236:239], v[64:79]
    buffer_load_dwordx4 v11, s[20:23], s51 offen offset:3072 lds
    s_add_u32 s51, s51, 114688
    v_exp_f32 v51, v51
    v_exp_f32 v52, v52
    v_exp_f32 v53, v53
    v_smfmac_f32_32x32x32_bf16 v[128:143], v[204:207], v[40:47], v3
    s_add_u32 m0, s53, 49152
    v_exp_f32 v54, v54
    v_exp_f32 v55, v55
    v_exp_f32 v56, v56
    v_exp_f32 v57, v57
    v_smfmac_f32_32x32x32_bf16 v[80:95], v[216:219], v[48:55], v3
    buffer_load_dwordx4 v[192:195], v2, s[32:35], s50 offen offset:0 sc1
    v_exp_f32 v58, v58
    v_exp_f32 v59, v59
    v_exp_f32 v60, v60
    v_exp_f32 v61, v61
    v_exp_f32 v62, v62
    v_exp_f32 v63, v63
    v_mfma_f32_32x32x16_bf16 v[32:47], v[208:211], a[240:243], 0
    v_exp_f32 v64, v64
    v_exp_f32 v65, v65
    v_exp_f32 v66, v66
    v_mfma_f32_32x32x16_bf16 v[32:47], v[212:215], a[244:247], v[32:47]
    buffer_load_dwordx4 v[196:199], v2, s[32:35], s50 offen offset:1024 sc1
    v_exp_f32 v67, v67
    v_exp_f32 v68, v68
    v_exp_f32 v69, v69
    v_smfmac_f32_32x32x32_bf16 v[80:95], v[220:223], v[56:63], v3
    buffer_load_dwordx4 v[200:203], v2, s[32:35], s50 offen offset:2048 sc1
    v_exp_f32 v70, v70
    v_exp_f32 v71, v71
    v_exp_f32 v72, v72
    v_exp_f32 v73, v73
    v_smfmac_f32_32x32x32_bf16 v[96:111], v[216:219], v[64:71], v3
    v_exp_f32 v74, v74
    v_exp_f32 v75, v75
    v_exp_f32 v76, v76
    v_exp_f32 v77, v77
    v_exp_f32 v78, v78
    v_exp_f32 v79, v79
    v_mfma_f32_32x32x16_bf16 v[48:63], v[208:211], a[248:251], 0
    buffer_load_dwordx4 v[204:207], v2, s[32:35], s50 offen offset:3072 sc1
    s_add_u32 s50, s50, 4096
    v_exp_f32 v32, v32
    v_exp_f32 v33, v33
    v_exp_f32 v34, v34
    v_mfma_f32_32x32x16_bf16 v[48:63], v[212:215], a[252:255], v[48:63]
    v_exp_f32 v35, v35
    v_exp_f32 v36, v36
    v_exp_f32 v37, v37
    v_smfmac_f32_32x32x32_bf16 v[96:111], v[220:223], v[72:79], v3
    buffer_load_dwordx4 v8, s[20:23], s51 offen offset:0 lds
    v_exp_f32 v38, v38
    v_exp_f32 v39, v39
    v_exp_f32 v40, v40
    v_exp_f32 v41, v41
    v_smfmac_f32_32x32x32_bf16 v[112:127], v[216:219], v[32:39], v3
    s_waitcnt vmcnt(25)
    v_exp_f32 v42, v42
    v_exp_f32 v43, v43
    v_exp_f32 v44, v44
    v_exp_f32 v45, v45
    v_exp_f32 v46, v46
    v_exp_f32 v47, v47
    v_mfma_f32_32x32x16_bf16 v[64:79], v[224:227], a[224:227], 0
    buffer_load_dwordx4 v9, s[20:23], s51 offen offset:1024 lds
    v_exp_f32 v48, v48
    v_exp_f32 v49, v49
    v_exp_f32 v50, v50
    v_mfma_f32_32x32x16_bf16 v[64:79], v[228:231], a[228:231], v[64:79]
    v_exp_f32 v51, v51
    v_exp_f32 v52, v52
    v_exp_f32 v53, v53
    v_smfmac_f32_32x32x32_bf16 v[112:127], v[220:223], v[40:47], v3
    buffer_load_dwordx4 v10, s[20:23], s51 offen offset:2048 lds
    v_exp_f32 v54, v54
    v_exp_f32 v55, v55
    v_exp_f32 v56, v56
    v_exp_f32 v57, v57
    v_smfmac_f32_32x32x32_bf16 v[128:143], v[216:219], v[48:55], v3
    buffer_load_dwordx4 v11, s[20:23], s51 offen offset:3072 lds
    s_add_u32 s51, s51, 114688
    v_exp_f32 v58, v58
    v_exp_f32 v59, v59
    v_exp_f32 v60, v60
    v_exp_f32 v61, v61
    v_exp_f32 v62, v62
    v_exp_f32 v63, v63
    v_mfma_f32_32x32x16_bf16 v[32:47], v[224:227], a[232:235], 0
    s_add_u32 m0, s53, 65536
    v_exp_f32 v64, v64
    v_exp_f32 v65, v65
    v_exp_f32 v66, v66
    v_mfma_f32_32x32x16_bf16 v[32:47], v[228:231], a[236:239], v[32:47]
    buffer_load_dwordx4 v8, s[20:23], s51 offen offset:0 lds
    v_exp_f32 v67, v67
    v_exp_f32 v68, v68
    v_exp_f32 v69, v69
    v_smfmac_f32_32x32x32_bf16 v[128:143], v[220:223], v[56:63], v3
    v_exp_f32 v70, v70
    v_exp_f32 v71, v71
    v_exp_f32 v72, v72
    v_exp_f32 v73, v73
    v_smfmac_f32_32x32x32_bf16 v[80:95], v[232:235], v[64:71], v3
    buffer_load_dwordx4 v[208:211], v2, s[32:35], s50 offen offset:0 sc1
    v_exp_f32 v74, v74
    v_exp_f32 v75, v75
    v_exp_f32 v76, v76
    v_exp_f32 v77, v77
    v_exp_f32 v78, v78
    v_exp_f32 v79, v79
    v_mfma_f32_32x32x16_bf16 v[48:63], v[224:227], a[240:243], 0
    v_exp_f32 v32, v32
    v_exp_f32 v33, v33
    v_exp_f32 v34, v34
    v_mfma_f32_32x32x16_bf16 v[48:63], v[228:231], a[244:247], v[48:63]
    buffer_load_dwordx4 v[212:215], v2, s[32:35], s50 offen offset:1024 sc1
    v_exp_f32 v35, v35
    v_exp_f32 v36, v36
    v_exp_f32 v37, v37
    v_smfmac_f32_32x32x32_bf16 v[80:95], v[236:239], v[72:79], v3
    v_exp_f32 v38, v38
    v_exp_f32 v39, v39
    v_exp_f32 v40, v40
    v_exp_f32 v41, v41
    v_smfmac_f32_32x32x32_bf16 v[96:111], v[232:235], v[32:39], v3
    buffer_load_dwordx4 v[216:219], v2, s[32:35], s50 offen offset:2048 sc1
    v_exp_f32 v42, v42
    v_exp_f32 v43, v43
    v_exp_f32 v44, v44
    v_exp_f32 v45, v45
    v_exp_f32 v46, v46
    v_exp_f32 v47, v47
    v_mfma_f32_32x32x16_bf16 v[64:79], v[224:227], a[248:251], 0
    v_exp_f32 v48, v48
    v_exp_f32 v49, v49
    v_exp_f32 v50, v50
    v_mfma_f32_32x32x16_bf16 v[64:79], v[228:231], a[252:255], v[64:79]
    buffer_load_dwordx4 v[220:223], v2, s[32:35], s50 offen offset:3072 sc1
    s_add_u32 s50, s50, 4096
    v_exp_f32 v51, v51
    v_exp_f32 v52, v52
    v_exp_f32 v53, v53
    v_smfmac_f32_32x32x32_bf16 v[96:111], v[236:239], v[40:47], v3
    buffer_load_dwordx4 v9, s[20:23], s51 offen offset:1024 lds
    v_exp_f32 v54, v54
    v_exp_f32 v55, v55
    v_exp_f32 v56, v56
    v_exp_f32 v57, v57
    v_smfmac_f32_32x32x32_bf16 v[112:127], v[232:235], v[48:55], v3
    s_waitcnt vmcnt(30)
    v_exp_f32 v58, v58
    v_exp_f32 v59, v59
    v_exp_f32 v60, v60
    v_exp_f32 v61, v61
    v_exp_f32 v62, v62
    v_exp_f32 v63, v63
    v_mfma_f32_32x32x16_bf16 v[32:47], v[144:147], a[224:227], 0
    buffer_load_dwordx4 v10, s[20:23], s51 offen offset:2048 lds
    v_exp_f32 v64, v64
    v_exp_f32 v65, v65
    v_exp_f32 v66, v66
    v_mfma_f32_32x32x16_bf16 v[32:47], v[148:151], a[228:231], v[32:47]
    v_exp_f32 v67, v67
    v_exp_f32 v68, v68
    v_exp_f32 v69, v69
    v_smfmac_f32_32x32x32_bf16 v[112:127], v[236:239], v[56:63], v3
    buffer_load_dwordx4 v11, s[20:23], s51 offen offset:3072 lds
    s_add_u32 s51, s51, 114688
    v_exp_f32 v70, v70
    v_exp_f32 v71, v71
    v_exp_f32 v72, v72
    v_exp_f32 v73, v73
    v_smfmac_f32_32x32x32_bf16 v[128:143], v[232:235], v[64:71], v3
    s_add_u32 m0, s53, 81920
    v_exp_f32 v74, v74
    v_exp_f32 v75, v75
    v_exp_f32 v76, v76
    v_exp_f32 v77, v77
    v_exp_f32 v78, v78
    v_exp_f32 v79, v79
    v_mfma_f32_32x32x16_bf16 v[48:63], v[144:147], a[232:235], 0
    s_waitcnt vmcnt(16)
    s_barrier
    v_exp_f32 v32, v32
    v_exp_f32 v33, v33
    v_exp_f32 v34, v34
    v_mfma_f32_32x32x16_bf16 v[48:63], v[148:151], a[236:239], v[48:63]
    ds_read_b64_tr_b16 a[0:1], v16 offset:16384
    buffer_load_dwordx4 v8, s[20:23], s51 offen offset:0 lds
    v_exp_f32 v35, v35
    v_exp_f32 v36, v36
    v_exp_f32 v37, v37
    v_smfmac_f32_32x32x32_bf16 v[128:143], v[236:239], v[72:79], v3
    ds_read_b64_tr_b16 a[2:3], v16 offset:18432
    buffer_load_dwordx4 v9, s[20:23], s51 offen offset:1024 lds
    v_exp_f32 v38, v38
    v_exp_f32 v39, v39
    v_exp_f32 v40, v40
    v_exp_f32 v41, v41
    v_smfmac_f32_32x32x32_bf16 v[80:95], v[152:155], v[32:39], v3
    ds_read_b64_tr_b16 a[4:5], v17 offset:16384
    buffer_load_dwordx4 v[224:227], v2, s[32:35], s50 offen offset:0 sc1
    v_exp_f32 v42, v42
    v_exp_f32 v43, v43
    v_exp_f32 v44, v44
    v_exp_f32 v45, v45
    v_exp_f32 v46, v46
    v_exp_f32 v47, v47
    v_mfma_f32_32x32x16_bf16 v[64:79], v[144:147], a[240:243], 0
    ds_read_b64_tr_b16 a[6:7], v17 offset:18432
    v_exp_f32 v48, v48
    v_exp_f32 v49, v49
    v_exp_f32 v50, v50
    v_mfma_f32_32x32x16_bf16 v[64:79], v[148:151], a[244:247], v[64:79]
    ds_read_b64_tr_b16 a[8:9], v16 offset:20480
    buffer_load_dwordx4 v[228:231], v2, s[32:35], s50 offen offset:1024 sc1
    v_exp_f32 v51, v51
    v_exp_f32 v52, v52
    v_exp_f32 v53, v53
    v_smfmac_f32_32x32x32_bf16 v[80:95], v[156:159], v[40:47], v3
    ds_read_b64_tr_b16 a[10:11], v16 offset:22528
    v_exp_f32 v54, v54
    v_exp_f32 v55, v55
    v_exp_f32 v56, v56
    v_exp_f32 v57, v57
    v_smfmac_f32_32x32x32_bf16 v[96:111], v[152:155], v[48:55], v3
    ds_read_b64_tr_b16 a[12:13], v17 offset:20480
    buffer_load_dwordx4 v[232:235], v2, s[32:35], s50 offen offset:2048 sc1
    v_exp_f32 v58, v58
    v_exp_f32 v59, v59
    v_exp_f32 v60, v60
    v_exp_f32 v61, v61
    v_exp_f32 v62, v62
    v_exp_f32 v63, v63
    v_mfma_f32_32x32x16_bf16 v[32:47], v[144:147], a[248:251], 0
    ds_read_b64_tr_b16 a[14:15], v17 offset:22528
    v_exp_f32 v64, v64
    v_exp_f32 v65, v65
    v_exp_f32 v66, v66
    v_mfma_f32_32x32x16_bf16 v[32:47], v[148:151], a[252:255], v[32:47]
    ds_read_b64_tr_b16 a[16:17], v16 offset:32768
    buffer_load_dwordx4 v[236:239], v2, s[32:35], s50 offen offset:3072 sc1
    s_add_u32 s50, s50, 4096
    v_exp_f32 v67, v67
    v_exp_f32 v68, v68
    v_exp_f32 v69, v69
    v_smfmac_f32_32x32x32_bf16 v[96:111], v[156:159], v[56:63], v3
    ds_read_b64_tr_b16 a[18:19], v16 offset:34816
    v_exp_f32 v70, v70
    v_exp_f32 v71, v71
    v_exp_f32 v72, v72
    v_exp_f32 v73, v73
    v_smfmac_f32_32x32x32_bf16 v[112:127], v[152:155], v[64:71], v3
    s_waitcnt vmcnt(34)
    ds_read_b64_tr_b16 a[20:21], v17 offset:32768
    buffer_load_dwordx4 v10, s[20:23], s51 offen offset:2048 lds
    v_exp_f32 v74, v74
    v_exp_f32 v75, v75
    v_exp_f32 v76, v76
    v_exp_f32 v77, v77
    v_exp_f32 v78, v78
    v_exp_f32 v79, v79
    v_mfma_f32_32x32x16_bf16 v[48:63], v[160:163], a[224:227], 0
    ds_read_b64_tr_b16 a[22:23], v17 offset:34816
    v_exp_f32 v32, v32
    v_exp_f32 v33, v33
    v_exp_f32 v34, v34
    v_mfma_f32_32x32x16_bf16 v[48:63], v[164:167], a[228:231], v[48:63]
    ds_read_b64_tr_b16 a[24:25], v16 offset:36864
    buffer_load_dwordx4 v11, s[20:23], s51 offen offset:3072 lds
    s_add_u32 s51, s51, 114688
    v_exp_f32 v35, v35
    v_exp_f32 v36, v36
    v_exp_f32 v37, v37
    v_smfmac_f32_32x32x32_bf16 v[112:127], v[156:159], v[72:79], v3
    s_add_u32 m0, s53, 0
    ds_read_b64_tr_b16 a[26:27], v16 offset:38912
    buffer_load_dwordx4 v8, s[20:23], s51 offen offset:0 lds
    v_exp_f32 v38, v38
    v_exp_f32 v39, v39
    v_exp_f32 v40, v40
    v_exp_f32 v41, v41
    v_smfmac_f32_32x32x32_bf16 v[128:143], v[152:155], v[32:39], v3
    ds_read_b64_tr_b16 a[28:29], v17 offset:36864
    v_exp_f32 v42, v42
    v_exp_f32 v43, v43
    v_exp_f32 v44, v44
    v_exp_f32 v45, v45
    v_exp_f32 v46, v46
    v_exp_f32 v47, v47
    v_mfma_f32_32x32x16_bf16 v[64:79], v[160:163], a[232:235], 0
    ds_read_b64_tr_b16 a[30:31], v17 offset:38912
    buffer_load_dwordx4 v9, s[20:23], s51 offen offset:1024 lds
    v_exp_f32 v48, v48
    v_exp_f32 v49, v49
    v_exp_f32 v50, v50
    v_mfma_f32_32x32x16_bf16 v[64:79], v[164:167], a[236:239], v[64:79]
    v_exp_f32 v51, v51
    v_exp_f32 v52, v52
    v_exp_f32 v53, v53
    v_smfmac_f32_32x32x32_bf16 v[128:143], v[156:159], v[40:47], v3
    buffer_load_dwordx4 v10, s[20:23], s51 offen offset:2048 lds
    v_exp_f32 v54, v54
    v_exp_f32 v55, v55
    v_exp_f32 v56, v56
    v_exp_f32 v57, v57
    v_smfmac_f32_32x32x32_bf16 v[80:95], v[168:171], v[48:55], v3
    v_exp_f32 v58, v58
    v_exp_f32 v59, v59
    v_exp_f32 v60, v60
    v_exp_f32 v61, v61
    v_exp_f32 v62, v62
    v_exp_f32 v63, v63
    v_mfma_f32_32x32x16_bf16 v[32:47], v[160:163], a[240:243], 0
    buffer_load_dwordx4 v[144:147], v2, s[32:35], s50 offen offset:0 sc1
    v_exp_f32 v64, v64
    v_exp_f32 v65, v65
    v_exp_f32 v66, v66
    v_mfma_f32_32x32x16_bf16 v[32:47], v[164:167], a[244:247], v[32:47]
    v_exp_f32 v67, v67
    v_exp_f32 v68, v68
    v_exp_f32 v69, v69
    v_smfmac_f32_32x32x32_bf16 v[80:95], v[172:175], v[56:63], v3
    buffer_load_dwordx4 v[148:151], v2, s[32:35], s50 offen offset:1024 sc1
    v_exp_f32 v70, v70
    v_exp_f32 v71, v71
    v_exp_f32 v72, v72
    v_exp_f32 v73, v73
    v_smfmac_f32_32x32x32_bf16 v[96:111], v[168:171], v[64:71], v3
    buffer_load_dwordx4 v[152:155], v2, s[32:35], s50 offen offset:2048 sc1
    v_exp_f32 v74, v74
    v_exp_f32 v75, v75
    v_exp_f32 v76, v76
    v_exp_f32 v77, v77
    v_exp_f32 v78, v78
    v_exp_f32 v79, v79
    v_mfma_f32_32x32x16_bf16 v[48:63], v[160:163], a[248:251], 0
sequential_preLN__softmax_full_mha__glu_gated_glu__prompt_kernel_pg3:
    s_cbranch_execz sequential_preLN__softmax_full_mha__glu_gated_glu__prompt_kernel_tb1
    s_waitcnt vmcnt(22) lgkmcnt(0)
    s_barrier
    v_exp_f32 v32, v32
    v_exp_f32 v33, v33
    v_exp_f32 v34, v34
    v_mfma_f32_32x32x16_bf16 v[48:63], v[164:167], a[252:255], v[48:63]
    ds_read_b64_tr_b16 a[32:33], v18 offset:0
    buffer_load_dwordx4 v[156:159], v2, s[32:35], s50 offen offset:3072 sc1
    s_add_u32 s50, s50, 4096
    v_exp_f32 v35, v35
    v_exp_f32 v36, v36
    v_exp_f32 v37, v37
    v_smfmac_f32_32x32x32_bf16 v[96:111], v[172:175], v[72:79], v3
    ds_read_b64_tr_b16 a[34:35], v18 offset:2048
    v_exp_f32 v38, v38
    v_exp_f32 v39, v39
    v_exp_f32 v40, v40
    v_exp_f32 v41, v41
    v_smfmac_f32_32x32x32_bf16 v[112:127], v[168:171], v[32:39], v3
    s_waitcnt vmcnt(35)
    ds_read_b64_tr_b16 a[36:37], v19 offset:0
    buffer_load_dwordx4 v11, s[20:23], s51 offen offset:3072 lds
    s_add_u32 s51, s51, 114688
    v_exp_f32 v42, v42
    v_exp_f32 v43, v43
    v_exp_f32 v44, v44
    v_exp_f32 v45, v45
    v_exp_f32 v46, v46
    v_exp_f32 v47, v47
    v_mfma_f32_32x32x16_bf16 v[64:79], v[176:179], a[224:227], 0
    s_add_u32 m0, s53, 16384
    ds_read_b64_tr_b16 a[38:39], v19 offset:2048
    v_exp_f32 v48, v48
    v_exp_f32 v49, v49
    v_exp_f32 v50, v50
    v_mfma_f32_32x32x16_bf16 v[64:79], v[180:183], a[228:231], v[64:79]
    ds_read_b64_tr_b16 a[40:41], v18 offset:4096
    buffer_load_dwordx4 v8, s[20:23], s51 offen offset:0 lds
    v_exp_f32 v51, v51
    v_exp_f32 v52, v52
    v_exp_f32 v53, v53
    v_smfmac_f32_32x32x32_bf16 v[112:127], v[172:175], v[40:47], v3
    ds_read_b64_tr_b16 a[42:43], v18 offset:6144
    v_exp_f32 v54, v54
    v_exp_f32 v55, v55
    v_exp_f32 v56, v56
    v_exp_f32 v57, v57
    v_smfmac_f32_32x32x32_bf16 v[128:143], v[168:171], v[48:55], v3
    ds_read_b64_tr_b16 a[44:45], v19 offset:4096
    buffer_load_dwordx4 v9, s[20:23], s51 offen offset:1024 lds
    v_exp_f32 v58, v58
    v_exp_f32 v59, v59
    v_exp_f32 v60, v60
    v_exp_f32 v61, v61
    v_exp_f32 v62, v62
    v_exp_f32 v63, v63
    v_mfma_f32_32x32x16_bf16 v[32:47], v[176:179], a[232:235], 0
    ds_read_b64_tr_b16 a[46:47], v19 offset:6144
    v_exp_f32 v64, v64
    v_exp_f32 v65, v65
    v_exp_f32 v66, v66
    v_mfma_f32_32x32x16_bf16 v[32:47], v[180:183], a[236:239], v[32:47]
    buffer_load_dwordx4 v10, s[20:23], s51 offen offset:2048 lds
    v_exp_f32 v67, v67
    v_exp_f32 v68, v68
    v_exp_f32 v69, v69
    v_smfmac_f32_32x32x32_bf16 v[128:143], v[172:175], v[56:63], v3
    buffer_load_dwordx4 v11, s[20:23], s51 offen offset:3072 lds
    s_add_u32 s51, s51, 114688
    v_exp_f32 v70, v70
    v_exp_f32 v71, v71
    v_exp_f32 v72, v72
    v_exp_f32 v73, v73
    v_smfmac_f32_32x32x32_bf16 v[80:95], v[184:187], v[64:71], v3
    s_add_u32 m0, s53, 32768
    v_exp_f32 v74, v74
    v_exp_f32 v75, v75
    v_exp_f32 v76, v76
    v_exp_f32 v77, v77
    v_exp_f32 v78, v78
    v_exp_f32 v79, v79
    v_mfma_f32_32x32x16_bf16 v[48:63], v[176:179], a[240:243], 0
    buffer_load_dwordx4 v[160:163], v2, s[32:35], s50 offen offset:0 sc1
    v_exp_f32 v32, v32
    v_exp_f32 v33, v33
    v_exp_f32 v34, v34
    v_mfma_f32_32x32x16_bf16 v[48:63], v[180:183], a[244:247], v[48:63]
    v_exp_f32 v35, v35
    v_exp_f32 v36, v36
    v_exp_f32 v37, v37
    v_smfmac_f32_32x32x32_bf16 v[80:95], v[188:191], v[72:79], v3
    buffer_load_dwordx4 v[164:167], v2, s[32:35], s50 offen offset:1024 sc1
    v_exp_f32 v38, v38
    v_exp_f32 v39, v39
    v_exp_f32 v40, v40
    v_exp_f32 v41, v41
    v_smfmac_f32_32x32x32_bf16 v[96:111], v[184:187], v[32:39], v3
    v_exp_f32 v42, v42
    v_exp_f32 v43, v43
    v_exp_f32 v44, v44
    v_exp_f32 v45, v45
    v_exp_f32 v46, v46
    v_exp_f32 v47, v47
    v_mfma_f32_32x32x16_bf16 v[64:79], v[176:179], a[248:251], 0
    buffer_load_dwordx4 v[168:171], v2, s[32:35], s50 offen offset:2048 sc1
    v_exp_f32 v48, v48
    v_exp_f32 v49, v49
    v_exp_f32 v50, v50
    v_mfma_f32_32x32x16_bf16 v[64:79], v[180:183], a[252:255], v[64:79]
    v_exp_f32 v51, v51
    v_exp_f32 v52, v52
    v_exp_f32 v53, v53
    v_smfmac_f32_32x32x32_bf16 v[96:111], v[188:191], v[40:47], v3
    buffer_load_dwordx4 v[172:175], v2, s[32:35], s50 offen offset:3072 sc1
    s_add_u32 s50, s50, 4096
    v_exp_f32 v54, v54
    v_exp_f32 v55, v55
    v_exp_f32 v56, v56
    v_exp_f32 v57, v57
    v_smfmac_f32_32x32x32_bf16 v[112:127], v[184:187], v[48:55], v3
    s_waitcnt vmcnt(36)
    buffer_load_dwordx4 v8, s[20:23], s51 offen offset:0 lds
    v_exp_f32 v58, v58
    v_exp_f32 v59, v59
    v_exp_f32 v60, v60
    v_exp_f32 v61, v61
    v_exp_f32 v62, v62
    v_exp_f32 v63, v63
    v_mfma_f32_32x32x16_bf16 v[32:47], v[192:195], a[224:227], 0
    v_exp_f32 v64, v64
    v_exp_f32 v65, v65
    v_exp_f32 v66, v66
    v_mfma_f32_32x32x16_bf16 v[32:47], v[196:199], a[228:231], v[32:47]
    buffer_load_dwordx4 v9, s[20:23], s51 offen offset:1024 lds
    v_exp_f32 v67, v67
    v_exp_f32 v68, v68
    v_exp_f32 v69, v69
    v_smfmac_f32_32x32x32_bf16 v[112:127], v[188:191], v[56:63], v3
    v_exp_f32 v70, v70
    v_exp_f32 v71, v71
    v_exp_f32 v72, v72
    v_exp_f32 v73, v73
    v_smfmac_f32_32x32x32_bf16 v[128:143], v[184:187], v[64:71], v3
    buffer_load_dwordx4 v10, s[20:23], s51 offen offset:2048 lds
    v_exp_f32 v74, v74
    v_exp_f32 v75, v75
    v_exp_f32 v76, v76
    v_exp_f32 v77, v77
    v_exp_f32 v78, v78
    v_exp_f32 v79, v79
    v_mfma_f32_32x32x16_bf16 v[48:63], v[192:195], a[232:235], 0
    s_waitcnt vmcnt(19) lgkmcnt(0)
    s_barrier
    v_exp_f32 v32, v32
    v_exp_f32 v33, v33
    v_exp_f32 v34, v34
    v_mfma_f32_32x32x16_bf16 v[48:63], v[196:199], a[236:239], v[48:63]
    ds_read_b64_tr_b16 a[48:49], v18 offset:16384
    buffer_load_dwordx4 v11, s[20:23], s51 offen offset:3072 lds
    s_add_u32 s51, s51, 114688
    v_exp_f32 v35, v35
    v_exp_f32 v36, v36
    v_exp_f32 v37, v37
    v_smfmac_f32_32x32x32_bf16 v[128:143], v[188:191], v[72:79], v3
    s_add_u32 m0, s53, 49152
    ds_read_b64_tr_b16 a[50:51], v18 offset:18432
    v_exp_f32 v38, v38
    v_exp_f32 v39, v39
    v_exp_f32 v40, v40
    v_exp_f32 v41, v41
    v_smfmac_f32_32x32x32_bf16 v[80:95], v[200:203], v[32:39], v3
    ds_read_b64_tr_b16 a[52:53], v19 offset:16384
    buffer_load_dwordx4 v[176:179], v2, s[32:35], s50 offen offset:0 sc1
    v_exp_f32 v42, v42
    v_exp_f32 v43, v43
    v_exp_f32 v44, v44
    v_exp_f32 v45, v45
    v_exp_f32 v46, v46
    v_exp_f32 v47, v47
    v_mfma_f32_32x32x16_bf16 v[64:79], v[192:195], a[240:243], 0
    ds_read_b64_tr_b16 a[54:55], v19 offset:18432
    v_exp_f32 v48, v48
    v_exp_f32 v49, v49
    v_exp_f32 v50, v50
    v_mfma_f32_32x32x16_bf16 v[64:79], v[196:199], a[244:247], v[64:79]
    ds_read_b64_tr_b16 a[56:57], v18 offset:20480
    buffer_load_dwordx4 v[180:183], v2, s[32:35], s50 offen offset:1024 sc1
    v_exp_f32 v51, v51
    v_exp_f32 v52, v52
    v_exp_f32 v53, v53
    v_smfmac_f32_32x32x32_bf16 v[80:95], v[204:207], v[40:47], v3
    ds_read_b64_tr_b16 a[58:59], v18 offset:22528
    buffer_load_dwordx4 v[184:187], v2, s[32:35], s50 offen offset:2048 sc1
    v_exp_f32 v54, v54
    v_exp_f32 v55, v55
    v_exp_f32 v56, v56
    v_exp_f32 v57, v57
    v_smfmac_f32_32x32x32_bf16 v[96:111], v[200:203], v[48:55], v3
    ds_read_b64_tr_b16 a[60:61], v19 offset:20480
    v_exp_f32 v58, v58
    v_exp_f32 v59, v59
    v_exp_f32 v60, v60
    v_exp_f32 v61, v61
    v_exp_f32 v62, v62
    v_exp_f32 v63, v63
    v_mfma_f32_32x32x16_bf16 v[32:47], v[192:195], a[248:251], 0
    ds_read_b64_tr_b16 a[62:63], v19 offset:22528
    buffer_load_dwordx4 v[188:191], v2, s[32:35], s50 offen offset:3072 sc1
    s_add_u32 s50, s50, 4096
    v_exp_f32 v64, v64
    v_exp_f32 v65, v65
    v_exp_f32 v66, v66
    v_mfma_f32_32x32x16_bf16 v[32:47], v[196:199], a[252:255], v[32:47]
    ds_read_b64_tr_b16 a[64:65], v18 offset:32768
    v_exp_f32 v67, v67
    v_exp_f32 v68, v68
    v_exp_f32 v69, v69
    v_smfmac_f32_32x32x32_bf16 v[96:111], v[204:207], v[56:63], v3
    ds_read_b64_tr_b16 a[66:67], v18 offset:34816
    buffer_load_dwordx4 v8, s[20:23], s51 offen offset:0 lds
    v_exp_f32 v70, v70
    v_exp_f32 v71, v71
    v_exp_f32 v72, v72
    v_exp_f32 v73, v73
    v_smfmac_f32_32x32x32_bf16 v[112:127], v[200:203], v[64:71], v3
    s_waitcnt vmcnt(36)
    ds_read_b64_tr_b16 a[68:69], v19 offset:32768
    v_exp_f32 v74, v74
    v_exp_f32 v75, v75
    v_exp_f32 v76, v76
    v_exp_f32 v77, v77
    v_exp_f32 v78, v78
    v_exp_f32 v79, v79
    v_mfma_f32_32x32x16_bf16 v[48:63], v[208:211], a[224:227], 0
    ds_read_b64_tr_b16 a[70:71], v19 offset:34816
    buffer_load_dwordx4 v9, s[20:23], s51 offen offset:1024 lds
    v_exp_f32 v32, v32
    v_exp_f32 v33, v33
    v_exp_f32 v34, v34
    v_mfma_f32_32x32x16_bf16 v[48:63], v[212:215], a[228:231], v[48:63]
    ds_read_b64_tr_b16 a[72:73], v18 offset:36864
    v_exp_f32 v35, v35
    v_exp_f32 v36, v36
    v_exp_f32 v37, v37
    v_smfmac_f32_32x32x32_bf16 v[112:127], v[204:207], v[72:79], v3
    ds_read_b64_tr_b16 a[74:75], v18 offset:38912
    buffer_load_dwordx4 v10, s[20:23], s51 offen offset:2048 lds
    v_exp_f32 v38, v38
    v_exp_f32 v39, v39
    v_exp_f32 v40, v40
    v_exp_f32 v41, v41
    v_smfmac_f32_32x32x32_bf16 v[128:143], v[200:203], v[32:39], v3
    ds_read_b64_tr_b16 a[76:77], v19 offset:36864
    buffer_load_dwordx4 v11, s[20:23], s51 offen offset:3072 lds
    s_add_u32 s51, s51, 114688
    v_exp_f32 v42, v42
    v_exp_f32 v43, v43
    v_exp_f32 v44, v44
    v_exp_f32 v45, v45
    v_exp_f32 v46, v46
    v_exp_f32 v47, v47
    v_mfma_f32_32x32x16_bf16 v[64:79], v[208:211], a[232:235], 0
    s_add_u32 m0, s53, 65536
    ds_read_b64_tr_b16 a[78:79], v19 offset:38912
    v_exp_f32 v48, v48
    v_exp_f32 v49, v49
    v_exp_f32 v50, v50
    v_mfma_f32_32x32x16_bf16 v[64:79], v[212:215], a[236:239], v[64:79]
    v_exp_f32 v51, v51
    v_exp_f32 v52, v52
    v_exp_f32 v53, v53
    v_smfmac_f32_32x32x32_bf16 v[128:143], v[204:207], v[40:47], v3
    v_exp_f32 v54, v54
    v_exp_f32 v55, v55
    v_exp_f32 v56, v56
    v_exp_f32 v57, v57
    v_smfmac_f32_32x32x32_bf16 v[80:95], v[216:219], v[48:55], v3
    buffer_load_dwordx4 v[192:195], v2, s[32:35], s50 offen offset:0 sc1
    v_exp_f32 v58, v58
    v_exp_f32 v59, v59
    v_exp_f32 v60, v60
    v_exp_f32 v61, v61
    v_exp_f32 v62, v62
    v_exp_f32 v63, v63
    v_mfma_f32_32x32x16_bf16 v[32:47], v[208:211], a[240:243], 0
    buffer_load_dwordx4 v[196:199], v2, s[32:35], s50 offen offset:1024 sc1
    v_exp_f32 v64, v64
    v_exp_f32 v65, v65
    v_exp_f32 v66, v66
    v_mfma_f32_32x32x16_bf16 v[32:47], v[212:215], a[244:247], v[32:47]
    buffer_load_dwordx4 v[200:203], v2, s[32:35], s50 offen offset:2048 sc1
    v_exp_f32 v67, v67
    v_exp_f32 v68, v68
    v_exp_f32 v69, v69
    v_smfmac_f32_32x32x32_bf16 v[80:95], v[220:223], v[56:63], v3
    v_exp_f32 v70, v70
    v_exp_f32 v71, v71
    v_exp_f32 v72, v72
    v_exp_f32 v73, v73
    v_smfmac_f32_32x32x32_bf16 v[96:111], v[216:219], v[64:71], v3
    buffer_load_dwordx4 v[204:207], v2, s[32:35], s50 offen offset:3072 sc1
    s_add_u32 s50, s50, 4096
    v_exp_f32 v74, v74
    v_exp_f32 v75, v75
    v_exp_f32 v76, v76
    v_exp_f32 v77, v77
    v_exp_f32 v78, v78
    v_exp_f32 v79, v79
    v_mfma_f32_32x32x16_bf16 v[48:63], v[208:211], a[248:251], 0
    s_waitcnt vmcnt(20) lgkmcnt(0)
    s_barrier
    v_exp_f32 v32, v32
    v_exp_f32 v33, v33
    v_exp_f32 v34, v34
    v_mfma_f32_32x32x16_bf16 v[48:63], v[212:215], a[252:255], v[48:63]
    ds_read_b64_tr_b16 a[80:81], v16 offset:0
    buffer_load_dwordx4 v8, s[20:23], s51 offen offset:0 lds
    v_exp_f32 v35, v35
    v_exp_f32 v36, v36
    v_exp_f32 v37, v37
    v_smfmac_f32_32x32x32_bf16 v[96:111], v[220:223], v[72:79], v3
    ds_read_b64_tr_b16 a[82:83], v16 offset:2048
    v_exp_f32 v38, v38
    v_exp_f32 v39, v39
    v_exp_f32 v40, v40
    v_exp_f32 v41, v41
    v_smfmac_f32_32x32x32_bf16 v[112:127], v[216:219], v[32:39], v3
    s_waitcnt vmcnt(35)
    ds_read_b64_tr_b16 a[84:85], v17 offset:0
    buffer_load_dwordx4 v9, s[20:23], s51 offen offset:1024 lds
    v_exp_f32 v42, v42
    v_exp_f32 v43, v43
    v_exp_f32 v44, v44
    v_exp_f32 v45, v45
    v_exp_f32 v46, v46
    v_exp_f32 v47, v47
    v_mfma_f32_32x32x16_bf16 v[64:79], v[224:227], a[224:227], 0
    ds_read_b64_tr_b16 a[86:87], v17 offset:2048
    v_exp_f32 v48, v48
    v_exp_f32 v49, v49
    v_exp_f32 v50, v50
    v_mfma_f32_32x32x16_bf16 v[64:79], v[228:231], a[228:231], v[64:79]
    ds_read_b64_tr_b16 a[88:89], v16 offset:4096
    buffer_load_dwordx4 v10, s[20:23], s51 offen offset:2048 lds
    v_exp_f32 v51, v51
    v_exp_f32 v52, v52
    v_exp_f32 v53, v53
    v_smfmac_f32_32x32x32_bf16 v[112:127], v[220:223], v[40:47], v3
    ds_read_b64_tr_b16 a[90:91], v16 offset:6144
    v_exp_f32 v54, v54
    v_exp_f32 v55, v55
    v_exp_f32 v56, v56
    v_exp_f32 v57, v57
    v_smfmac_f32_32x32x32_bf16 v[128:143], v[216:219], v[48:55], v3
    ds_read_b64_tr_b16 a[92:93], v17 offset:4096
    buffer_load_dwordx4 v11, s[20:23], s51 offen offset:3072 lds
    s_add_u32 s51, s51, 114688
    v_exp_f32 v58, v58
    v_exp_f32 v59, v59
    v_exp_f32 v60, v60
    v_exp_f32 v61, v61
    v_exp_f32 v62, v62
    v_exp_f32 v63, v63
    v_mfma_f32_32x32x16_bf16 v[32:47], v[224:227], a[232:235], 0
    s_add_u32 m0, s53, 81920
    ds_read_b64_tr_b16 a[94:95], v17 offset:6144
    buffer_load_dwordx4 v8, s[20:23], s51 offen offset:0 lds
    v_exp_f32 v64, v64
    v_exp_f32 v65, v65
    v_exp_f32 v66, v66
    v_mfma_f32_32x32x16_bf16 v[32:47], v[228:231], a[236:239], v[32:47]
    ds_read_b64_tr_b16 a[96:97], v16 offset:16384
    v_exp_f32 v67, v67
    v_exp_f32 v68, v68
    v_exp_f32 v69, v69
    v_smfmac_f32_32x32x32_bf16 v[128:143], v[220:223], v[56:63], v3
    ds_read_b64_tr_b16 a[98:99], v16 offset:18432
    buffer_load_dwordx4 v9, s[20:23], s51 offen offset:1024 lds
    v_exp_f32 v70, v70
    v_exp_f32 v71, v71
    v_exp_f32 v72, v72
    v_exp_f32 v73, v73
    v_smfmac_f32_32x32x32_bf16 v[80:95], v[232:235], v[64:71], v3
    ds_read_b64_tr_b16 a[100:101], v17 offset:16384
    v_exp_f32 v74, v74
    v_exp_f32 v75, v75
    v_exp_f32 v76, v76
    v_exp_f32 v77, v77
    v_exp_f32 v78, v78
    v_exp_f32 v79, v79
    v_mfma_f32_32x32x16_bf16 v[48:63], v[224:227], a[240:243], 0
    ds_read_b64_tr_b16 a[102:103], v17 offset:18432
    buffer_load_dwordx4 v10, s[20:23], s51 offen offset:2048 lds
    v_exp_f32 v32, v32
    v_exp_f32 v33, v33
    v_exp_f32 v34, v34
    v_mfma_f32_32x32x16_bf16 v[48:63], v[228:231], a[244:247], v[48:63]
    ds_read_b64_tr_b16 a[104:105], v16 offset:20480
    v_exp_f32 v35, v35
    v_exp_f32 v36, v36
    v_exp_f32 v37, v37
    v_smfmac_f32_32x32x32_bf16 v[80:95], v[236:239], v[72:79], v3
    ds_read_b64_tr_b16 a[106:107], v16 offset:22528
    buffer_load_dwordx4 v11, s[20:23], s51 offen offset:3072 lds
    s_add_u32 s51, s51, 114688
    v_exp_f32 v38, v38
    v_exp_f32 v39, v39
    v_exp_f32 v40, v40
    v_exp_f32 v41, v41
    v_smfmac_f32_32x32x32_bf16 v[96:111], v[232:235], v[32:39], v3
    s_add_u32 m0, s54, 0
    ds_read_b64_tr_b16 a[108:109], v17 offset:20480
    v_exp_f32 v42, v42
    v_exp_f32 v43, v43
    v_exp_f32 v44, v44
    v_exp_f32 v45, v45
    v_exp_f32 v46, v46
    v_exp_f32 v47, v47
    v_mfma_f32_32x32x16_bf16 v[64:79], v[224:227], a[248:251], 0
    ds_read_b64_tr_b16 a[110:111], v17 offset:22528
    buffer_load_dwordx4 v12, s[16:19], s52 offen offset:0 lds
    v_exp_f32 v48, v48
    v_exp_f32 v49, v49
    v_exp_f32 v50, v50
    v_mfma_f32_32x32x16_bf16 v[64:79], v[228:231], a[252:255], v[64:79]
    buffer_load_dwordx4 v13, s[16:19], s52 offen offset:1024 lds
    v_exp_f32 v51, v51
    v_exp_f32 v52, v52
    v_exp_f32 v53, v53
    v_smfmac_f32_32x32x32_bf16 v[96:111], v[236:239], v[40:47], v3
    v_exp_f32 v54, v54
    v_exp_f32 v55, v55
    v_exp_f32 v56, v56
    v_exp_f32 v57, v57
    v_smfmac_f32_32x32x32_bf16 v[112:127], v[232:235], v[48:55], v3
    s_waitcnt vmcnt(35)
    buffer_load_dwordx4 v14, s[16:19], s52 offen offset:2048 lds
    v_exp_f32 v58, v58
    v_exp_f32 v59, v59
    v_exp_f32 v60, v60
    v_exp_f32 v61, v61
    v_exp_f32 v62, v62
    v_exp_f32 v63, v63
    v_mfma_f32_32x32x16_bf16 v[32:47], v[144:147], a[224:227], 0
    s_waitcnt vmcnt(15) lgkmcnt(0)
    s_barrier
    v_exp_f32 v64, v64
    v_exp_f32 v65, v65
    v_exp_f32 v66, v66
    v_mfma_f32_32x32x16_bf16 v[32:47], v[148:151], a[228:231], v[32:47]
    ds_read_b64_tr_b16 a[112:113], v16 offset:32768
    buffer_load_dwordx4 v15, s[16:19], s52 offen offset:3072 lds
    s_add_u32 s52, s52, 28672
    v_exp_f32 v67, v67
    v_exp_f32 v68, v68
    v_exp_f32 v69, v69
    v_smfmac_f32_32x32x32_bf16 v[112:127], v[236:239], v[56:63], v3
    s_add_u32 m0, s53, 0
    ds_read_b64_tr_b16 a[114:115], v16 offset:34816
    v_exp_f32 v70, v70
    v_exp_f32 v71, v71
    v_exp_f32 v72, v72
    v_exp_f32 v73, v73
    v_smfmac_f32_32x32x32_bf16 v[128:143], v[232:235], v[64:71], v3
    ds_read_b64_tr_b16 a[116:117], v17 offset:32768
    buffer_load_dwordx4 v8, s[20:23], s51 offen offset:0 lds
    v_exp_f32 v74, v74
    v_exp_f32 v75, v75
    v_exp_f32 v76, v76
    v_exp_f32 v77, v77
    v_exp_f32 v78, v78
    v_exp_f32 v79, v79
    v_mfma_f32_32x32x16_bf16 v[48:63], v[144:147], a[232:235], 0
    ds_read_b64_tr_b16 a[118:119], v17 offset:34816
    v_exp_f32 v32, v32
    v_exp_f32 v33, v33
    v_exp_f32 v34, v34
    v_mfma_f32_32x32x16_bf16 v[48:63], v[148:151], a[236:239], v[48:63]
    ds_read_b64_tr_b16 a[120:121], v16 offset:36864
    buffer_load_dwordx4 v9, s[20:23], s51 offen offset:1024 lds
    v_exp_f32 v35, v35
    v_exp_f32 v36, v36
    v_exp_f32 v37, v37
    v_smfmac_f32_32x32x32_bf16 v[128:143], v[236:239], v[72:79], v3
    ds_read_b64_tr_b16 a[122:123], v16 offset:38912
    v_exp_f32 v38, v38
    v_exp_f32 v39, v39
    v_exp_f32 v40, v40
    v_exp_f32 v41, v41
    v_smfmac_f32_32x32x32_bf16 v[80:95], v[152:155], v[32:39], v3
    ds_read_b64_tr_b16 a[124:125], v17 offset:36864
    buffer_load_dwordx4 v10, s[20:23], s51 offen offset:2048 lds
    v_exp_f32 v42, v42
    v_exp_f32 v43, v43
    v_exp_f32 v44, v44
    v_exp_f32 v45, v45
    v_exp_f32 v46, v46
    v_exp_f32 v47, v47
    v_mfma_f32_32x32x16_bf16 v[64:79], v[144:147], a[240:243], 0
    ds_read_b64_tr_b16 a[126:127], v17 offset:38912
    buffer_load_dwordx4 v11, s[20:23], s51 offen offset:3072 lds
    s_add_u32 s51, s51, 114688
    v_exp_f32 v48, v48
    v_exp_f32 v49, v49
    v_exp_f32 v50, v50
    v_mfma_f32_32x32x16_bf16 v[64:79], v[148:151], a[244:247], v[64:79]
    s_add_u32 m0, s54, 4096
    ds_read_b64_tr_b16 a[128:129], v18 offset:0
    v_exp_f32 v51, v51
    v_exp_f32 v52, v52
    v_exp_f32 v53, v53
    v_smfmac_f32_32x32x32_bf16 v[80:95], v[156:159], v[40:47], v3
    ds_read_b64_tr_b16 a[130:131], v18 offset:2048
    buffer_load_dwordx4 v12, s[16:19], s52 offen offset:0 lds
    v_exp_f32 v54, v54
    v_exp_f32 v55, v55
    v_exp_f32 v56, v56
    v_exp_f32 v57, v57
    v_smfmac_f32_32x32x32_bf16 v[96:111], v[152:155], v[48:55], v3
    s_waitcnt vmcnt(33)
    ds_read_b64_tr_b16 a[132:133], v19 offset:0
    v_exp_f32 v58, v58
    v_exp_f32 v59, v59
    v_exp_f32 v60, v60
    v_exp_f32 v61, v61
    v_exp_f32 v62, v62
    v_exp_f32 v63, v63
    v_mfma_f32_32x32x16_bf16 v[32:47], v[160:163], a[224:227], 0
    ds_read_b64_tr_b16 a[134:135], v19 offset:2048
    buffer_load_dwordx4 v13, s[16:19], s52 offen offset:1024 lds
    v_exp_f32 v64, v64
    v_exp_f32 v65, v65
    v_exp_f32 v66, v66
    v_mfma_f32_32x32x16_bf16 v[32:47], v[164:167], a[228:231], v[32:47]
    ds_read_b64_tr_b16 a[136:137], v18 offset:4096
    v_exp_f32 v67, v67
    v_exp_f32 v68, v68
    v_exp_f32 v69, v69
    v_smfmac_f32_32x32x32_bf16 v[96:111], v[156:159], v[56:63], v3
    ds_read_b64_tr_b16 a[138:139], v18 offset:6144
    buffer_load_dwordx4 v14, s[16:19], s52 offen offset:2048 lds
    v_exp_f32 v70, v70
    v_exp_f32 v71, v71
    v_exp_f32 v72, v72
    v_exp_f32 v73, v73
    v_smfmac_f32_32x32x32_bf16 v[112:127], v[152:155], v[64:71], v3
    ds_read_b64_tr_b16 a[140:141], v19 offset:4096
    v_exp_f32 v74, v74
    v_exp_f32 v75, v75
    v_exp_f32 v76, v76
    v_exp_f32 v77, v77
    v_exp_f32 v78, v78
    v_exp_f32 v79, v79
    v_mfma_f32_32x32x16_bf16 v[48:63], v[160:163], a[232:235], 0
    ds_read_b64_tr_b16 a[142:143], v19 offset:6144
    buffer_load_dwordx4 v15, s[16:19], s52 offen offset:3072 lds
    s_add_u32 s52, s52, 28672
    v_exp_f32 v32, v32
    v_exp_f32 v33, v33
    v_exp_f32 v34, v34
    v_mfma_f32_32x32x16_bf16 v[48:63], v[164:167], a[236:239], v[48:63]
    s_add_u32 m0, s54, 8192
    v_exp_f32 v35, v35
    v_exp_f32 v36, v36
    v_exp_f32 v37, v37
    v_smfmac_f32_32x32x32_bf16 v[112:127], v[156:159], v[72:79], v3
    buffer_load_dwordx4 v12, s[16:19], s52 offen offset:0 lds
    v_exp_f32 v38, v38
    v_exp_f32 v39, v39
    v_exp_f32 v40, v40
    v_exp_f32 v41, v41
    v_smfmac_f32_32x32x32_bf16 v[80:95], v[168:171], v[32:39], v3
    buffer_load_dwordx4 v13, s[16:19], s52 offen offset:1024 lds
    v_exp_f32 v42, v42
    v_exp_f32 v43, v43
    v_exp_f32 v44, v44
    v_exp_f32 v45, v45
    v_exp_f32 v46, v46
    v_exp_f32 v47, v47
    v_mfma_f32_32x32x16_bf16 v[64:79], v[160:163], a[240:243], 0
    v_exp_f32 v48, v48
    v_exp_f32 v49, v49
    v_exp_f32 v50, v50
    v_mfma_f32_32x32x16_bf16 v[64:79], v[164:167], a[244:247], v[64:79]
    buffer_load_dwordx4 v14, s[16:19], s52 offen offset:2048 lds
    v_exp_f32 v51, v51
    v_exp_f32 v52, v52
    v_exp_f32 v53, v53
    v_smfmac_f32_32x32x32_bf16 v[80:95], v[172:175], v[40:47], v3
    v_exp_f32 v54, v54
    v_exp_f32 v55, v55
    v_exp_f32 v56, v56
    v_exp_f32 v57, v57
    v_smfmac_f32_32x32x32_bf16 v[96:111], v[168:171], v[48:55], v3
    s_waitcnt vmcnt(31)
    buffer_load_dwordx4 v15, s[16:19], s52 offen offset:3072 lds
    s_add_u32 s52, s52, 28672
    v_exp_f32 v58, v58
    v_exp_f32 v59, v59
    v_exp_f32 v60, v60
    v_exp_f32 v61, v61
    v_exp_f32 v62, v62
    v_exp_f32 v63, v63
    v_mfma_f32_32x32x16_bf16 v[32:47], v[176:179], a[224:227], 0
    s_waitcnt vmcnt(16) lgkmcnt(0)
    s_barrier
    v_exp_f32 v64, v64
    v_exp_f32 v65, v65
    v_exp_f32 v66, v66
    v_mfma_f32_32x32x16_bf16 v[32:47], v[180:183], a[228:231], v[32:47]
    s_add_u32 m0, s54, 12288
    ds_read_b64_tr_b16 a[144:145], v18 offset:16384
    buffer_load_dwordx4 v12, s[16:19], s52 offen offset:0 lds
    v_exp_f32 v67, v67
    v_exp_f32 v68, v68
    v_exp_f32 v69, v69
    v_smfmac_f32_32x32x32_bf16 v[96:111], v[172:175], v[56:63], v3
    ds_read_b64_tr_b16 a[146:147], v18 offset:18432
    v_exp_f32 v70, v70
    v_exp_f32 v71, v71
    v_exp_f32 v72, v72
    v_exp_f32 v73, v73
    v_smfmac_f32_32x32x32_bf16 v[112:127], v[168:171], v[64:71], v3
    ds_read_b64_tr_b16 a[148:149], v19 offset:16384
    buffer_load_dwordx4 v13, s[16:19], s52 offen offset:1024 lds
    s_add_u32 s52, s52, 28672
    v_exp_f32 v74, v74
    v_exp_f32 v75, v75
    v_exp_f32 v76, v76
    v_exp_f32 v77, v77
    v_exp_f32 v78, v78
    v_exp_f32 v79, v79
    v_mfma_f32_32x32x16_bf16 v[48:63], v[176:179], a[232:235], 0
    s_add_u32 m0, s53, 16384
    ds_read_b64_tr_b16 a[150:151], v19 offset:18432
    buffer_load_dwordx4 v8, s[20:23], s51 offen offset:0 lds
    v_exp_f32 v32, v32
    v_exp_f32 v33, v33
    v_exp_f32 v34, v34
    v_mfma_f32_32x32x16_bf16 v[48:63], v[180:183], a[236:239], v[48:63]
    ds_read_b64_tr_b16 a[152:153], v18 offset:20480
    v_exp_f32 v35, v35
    v_exp_f32 v36, v36
    v_exp_f32 v37, v37
    v_smfmac_f32_32x32x32_bf16 v[112:127], v[172:175], v[72:79], v3
    ds_read_b64_tr_b16 a[154:155], v18 offset:22528
    buffer_load_dwordx4 v9, s[20:23], s51 offen offset:1024 lds
    v_exp_f32 v38, v38
    v_exp_f32 v39, v39
    v_exp_f32 v40, v40
    v_exp_f32 v41, v41
    v_smfmac_f32_32x32x32_bf16 v[80:95], v[184:187], v[32:39], v3
    ds_read_b64_tr_b16 a[156:157], v19 offset:20480
    v_exp_f32 v42, v42
    v_exp_f32 v43, v43
    v_exp_f32 v44, v44
    v_exp_f32 v45, v45
    v_exp_f32 v46, v46
    v_exp_f32 v47, v47
    v_mfma_f32_32x32x16_bf16 v[64:79], v[176:179], a[240:243], 0
    ds_read_b64_tr_b16 a[158:159], v19 offset:22528
    buffer_load_dwordx4 v10, s[20:23], s51 offen offset:2048 lds
    v_exp_f32 v48, v48
    v_exp_f32 v49, v49
    v_exp_f32 v50, v50
    v_mfma_f32_32x32x16_bf16 v[64:79], v[180:183], a[244:247], v[64:79]
    ds_read_b64_tr_b16 a[160:161], v18 offset:32768
    v_exp_f32 v51, v51
    v_exp_f32 v52, v52
    v_exp_f32 v53, v53
    v_smfmac_f32_32x32x32_bf16 v[80:95], v[188:191], v[40:47], v3
    ds_read_b64_tr_b16 a[162:163], v18 offset:34816
    buffer_load_dwordx4 v11, s[20:23], s51 offen offset:3072 lds
    s_add_u32 s51, s51, 114688
    v_exp_f32 v54, v54
    v_exp_f32 v55, v55
    v_exp_f32 v56, v56
    v_exp_f32 v57, v57
    v_smfmac_f32_32x32x32_bf16 v[96:111], v[184:187], v[48:55], v3
    s_add_u32 m0, s53, 32768
    s_waitcnt vmcnt(30)
    ds_read_b64_tr_b16 a[164:165], v19 offset:32768
    v_exp_f32 v58, v58
    v_exp_f32 v59, v59
    v_exp_f32 v60, v60
    v_exp_f32 v61, v61
    v_exp_f32 v62, v62
    v_exp_f32 v63, v63
    v_mfma_f32_32x32x16_bf16 v[32:47], v[192:195], a[224:227], 0
    ds_read_b64_tr_b16 a[166:167], v19 offset:34816
    buffer_load_dwordx4 v8, s[20:23], s51 offen offset:0 lds
    v_exp_f32 v64, v64
    v_exp_f32 v65, v65
    v_exp_f32 v66, v66
    v_mfma_f32_32x32x16_bf16 v[32:47], v[196:199], a[228:231], v[32:47]
    ds_read_b64_tr_b16 a[168:169], v18 offset:36864
    buffer_load_dwordx4 v9, s[20:23], s51 offen offset:1024 lds
    v_exp_f32 v67, v67
    v_exp_f32 v68, v68
    v_exp_f32 v69, v69
    v_smfmac_f32_32x32x32_bf16 v[96:111], v[188:191], v[56:63], v3
    ds_read_b64_tr_b16 a[170:171], v18 offset:38912
    v_exp_f32 v70, v70
    v_exp_f32 v71, v71
    v_exp_f32 v72, v72
    v_exp_f32 v73, v73
    v_smfmac_f32_32x32x32_bf16 v[112:127], v[184:187], v[64:71], v3
    ds_read_b64_tr_b16 a[172:173], v19 offset:36864
    buffer_load_dwordx4 v10, s[20:23], s51 offen offset:2048 lds
    v_exp_f32 v74, v74
    v_exp_f32 v75, v75
    v_exp_f32 v76, v76
    v_exp_f32 v77, v77
    v_exp_f32 v78, v78
    v_exp_f32 v79, v79
    v_mfma_f32_32x32x16_bf16 v[48:63], v[192:195], a[232:235], 0
    ds_read_b64_tr_b16 a[174:175], v19 offset:38912
    v_exp_f32 v32, v32
    v_exp_f32 v33, v33
    v_exp_f32 v34, v34
    v_mfma_f32_32x32x16_bf16 v[48:63], v[196:199], a[236:239], v[48:63]
    buffer_load_dwordx4 v11, s[20:23], s51 offen offset:3072 lds
    s_add_u32 s51, s51, 114688
    v_exp_f32 v35, v35
    v_exp_f32 v36, v36
    v_exp_f32 v37, v37
    v_smfmac_f32_32x32x32_bf16 v[112:127], v[188:191], v[72:79], v3
    s_add_u32 s4, s55, 57344
    v_exp_f32 v38, v38
    v_exp_f32 v39, v39
    v_exp_f32 v40, v40
    v_exp_f32 v41, v41
    v_smfmac_f32_32x32x32_bf16 v[80:95], v[200:203], v[32:39], v3
    buffer_load_dwordx4 v[240:243], v28, s[8:11], s55 offen
    v_exp_f32 v42, v42
    v_exp_f32 v43, v43
    v_exp_f32 v44, v44
    v_exp_f32 v45, v45
    v_exp_f32 v46, v46
    v_exp_f32 v47, v47
    v_mfma_f32_32x32x16_bf16 v[64:79], v[192:195], a[240:243], 0
    s_waitcnt vmcnt(19) lgkmcnt(0)
    s_barrier
    v_exp_f32 v48, v48
    v_exp_f32 v49, v49
    v_exp_f32 v50, v50
    v_mfma_f32_32x32x16_bf16 v[64:79], v[196:199], a[244:247], v[64:79]
sequential_preLN__softmax_full_mha__glu_gated_glu__prompt_kernel_pg4:
    s_cbranch_execz sequential_preLN__softmax_full_mha__glu_gated_glu__prompt_kernel_tb1
    ds_read_b64_tr_b16 a[176:177], v16 offset:0
    buffer_load_dwordx4 v[244:247], v28, s[8:11], s4 offen
    v_exp_f32 v51, v51
    v_exp_f32 v52, v52
    v_exp_f32 v53, v53
    v_smfmac_f32_32x32x32_bf16 v[80:95], v[204:207], v[40:47], v3
    ds_read_b64_tr_b16 a[178:179], v16 offset:2048
    v_exp_f32 v54, v54
    v_exp_f32 v55, v55
    v_exp_f32 v56, v56
    v_exp_f32 v57, v57
    v_smfmac_f32_32x32x32_bf16 v[96:111], v[200:203], v[48:55], v3
    ds_read_b64_tr_b16 a[180:181], v17 offset:0
    v_exp_f32 v58, v58
    v_exp_f32 v59, v59
    v_exp_f32 v60, v60
    v_exp_f32 v61, v61
    v_exp_f32 v62, v62
    v_exp_f32 v63, v63
    v_mfma_f32_32x32x16_bf16 v[32:47], v[144:147], a[248:251], 0
    ds_write_b128 v24, v[80:83] offset:0
    v_exp_f32 v64, v64
    v_exp_f32 v65, v65
    v_exp_f32 v66, v66
    v_mfma_f32_32x32x16_bf16 v[32:47], v[148:151], a[252:255], v[32:47]
    ds_write_b128 v24, v[84:87] offset:1024
    v_exp_f32 v67, v67
    v_exp_f32 v68, v68
    v_exp_f32 v69, v69
    v_smfmac_f32_32x32x32_bf16 v[96:111], v[204:207], v[56:63], v3
    ds_write_b128 v24, v[88:91] offset:2048
    v_exp_f32 v70, v70
    v_exp_f32 v71, v71
    v_exp_f32 v72, v72
    v_exp_f32 v73, v73
    v_smfmac_f32_32x32x32_bf16 v[112:127], v[200:203], v[64:71], v3
    ds_write_b128 v24, v[92:95] offset:3072
    v_exp_f32 v74, v74
    v_exp_f32 v75, v75
    v_exp_f32 v76, v76
    v_exp_f32 v77, v77
    v_exp_f32 v78, v78
    v_exp_f32 v79, v79
    v_mfma_f32_32x32x16_bf16 v[48:63], v[160:163], a[248:251], 0
    ds_write_b128 v25, v[96:99] offset:0
    v_exp_f32 v32, v32
    v_exp_f32 v33, v33
    v_exp_f32 v34, v34
    v_mfma_f32_32x32x16_bf16 v[48:63], v[164:167], a[252:255], v[48:63]
    ds_write_b128 v25, v[100:103] offset:1024
    v_exp_f32 v35, v35
    v_exp_f32 v36, v36
    v_exp_f32 v37, v37
    v_smfmac_f32_32x32x32_bf16 v[112:127], v[204:207], v[72:79], v3
    ds_write_b128 v25, v[104:107] offset:2048
    v_exp_f32 v38, v38
    v_exp_f32 v39, v39
    v_exp_f32 v40, v40
    v_exp_f32 v41, v41
    v_smfmac_f32_32x32x32_bf16 v[128:143], v[152:155], v[32:39], v3
    ds_write_b128 v25, v[108:111] offset:3072
    v_exp_f32 v42, v42
    v_exp_f32 v43, v43
    v_exp_f32 v44, v44
    v_exp_f32 v45, v45
    v_exp_f32 v46, v46
    v_exp_f32 v47, v47
    v_mfma_f32_32x32x16_bf16 v[64:79], v[176:179], a[248:251], 0
    ds_write_b128 v26, v[112:115] offset:0
    v_exp_f32 v48, v48
    v_exp_f32 v49, v49
    v_exp_f32 v50, v50
    v_mfma_f32_32x32x16_bf16 v[64:79], v[180:183], a[252:255], v[64:79]
    ds_write_b128 v26, v[116:119] offset:1024
    v_exp_f32 v51, v51
    v_exp_f32 v52, v52
    v_exp_f32 v53, v53
    v_smfmac_f32_32x32x32_bf16 v[128:143], v[156:159], v[40:47], v3
    ds_write_b128 v26, v[120:123] offset:2048
    v_exp_f32 v54, v54
    v_exp_f32 v55, v55
    v_exp_f32 v56, v56
    v_exp_f32 v57, v57
    v_smfmac_f32_32x32x32_bf16 v[128:143], v[168:171], v[48:55], v3
    ds_write_b128 v26, v[124:127] offset:3072
    v_exp_f32 v58, v58
    v_exp_f32 v59, v59
    v_exp_f32 v60, v60
    v_exp_f32 v61, v61
    v_exp_f32 v62, v62
    v_exp_f32 v63, v63
    v_mfma_f32_32x32x16_bf16 v[32:47], v[192:195], a[248:251], 0
    v_exp_f32 v64, v64
    v_exp_f32 v65, v65
    v_exp_f32 v66, v66
    v_mfma_f32_32x32x16_bf16 v[32:47], v[196:199], a[252:255], v[32:47]
    s_waitcnt vmcnt(10) lgkmcnt(0)
    s_barrier
    v_exp_f32 v67, v67
    v_exp_f32 v68, v68
    v_exp_f32 v69, v69
    v_smfmac_f32_32x32x32_bf16 v[128:143], v[172:175], v[56:63], v3
    ds_read_b128 v[84:87], v27 offset:1024
    ds_read_b128 v[100:103], v27 offset:5120
    v_exp_f32 v70, v70
    v_exp_f32 v71, v71
    v_exp_f32 v72, v72
    v_exp_f32 v73, v73
    v_smfmac_f32_32x32x32_bf16 v[128:143], v[184:187], v[64:71], v3
    ds_read_b128 v[116:119], v27 offset:9216
    ds_read_b128 v[80:83], v27 offset:0
    v_exp_f32 v74, v74
    v_exp_f32 v75, v75
    v_exp_f32 v76, v76
    v_exp_f32 v77, v77
    v_exp_f32 v78, v78
    v_exp_f32 v79, v79
    ds_read_b128 v[96:99], v27 offset:4096
    ds_read_b128 v[112:115], v27 offset:8192
    v_exp_f32 v32, v32
    v_exp_f32 v33, v33
    v_exp_f32 v34, v34
    ds_read_b128 v[88:91], v27 offset:2048
    ds_read_b128 v[104:107], v27 offset:6144
    v_exp_f32 v35, v35
    v_exp_f32 v36, v36
    v_exp_f32 v37, v37
    v_smfmac_f32_32x32x32_bf16 v[128:143], v[188:191], v[72:79], v3
    ds_read_b128 v[120:123], v27 offset:10240
    ds_read_b128 v[92:95], v27 offset:3072
    v_exp_f32 v38, v38
    v_exp_f32 v39, v39
    v_exp_f32 v40, v40
    v_exp_f32 v41, v41
    v_smfmac_f32_32x32x32_bf16 v[128:143], v[200:203], v[32:39], v3
    ds_read_b128 v[108:111], v27 offset:7168
    ds_read_b128 v[124:127], v27 offset:11264
    v_exp_f32 v42, v42
    v_exp_f32 v43, v43
    v_exp_f32 v44, v44
    v_exp_f32 v45, v45
    v_exp_f32 v46, v46
    v_exp_f32 v47, v47
    s_nop 1
    v_smfmac_f32_32x32x32_bf16 v[128:143], v[204:207], v[40:47], v3
    s_mov_b32 s4, 0x2b800000
    s_mov_b32 s5, 0x53800000
    s_waitcnt lgkmcnt(9)
    v_pk_add_f32 v[84:85], v[84:85], v[100:101]
    v_pk_add_f32 v[86:87], v[86:87], v[102:103]
    v_pk_add_f32 v[84:85], v[84:85], v[116:117]
    v_pk_add_f32 v[86:87], v[86:87], v[118:119]
    s_waitcnt lgkmcnt(6)
    v_pk_add_f32 v[80:81], v[80:81], v[96:97]
    v_pk_add_f32 v[82:83], v[82:83], v[98:99]
    v_pk_add_f32 v[80:81], v[80:81], v[112:113]
    v_pk_add_f32 v[82:83], v[82:83], v[114:115]
    s_waitcnt lgkmcnt(3)
    v_pk_add_f32 v[88:89], v[88:89], v[104:105]
    v_pk_add_f32 v[90:91], v[90:91], v[106:107]
    v_pk_add_f32 v[88:89], v[88:89], v[120:121]
    v_pk_add_f32 v[90:91], v[90:91], v[122:123]
    s_waitcnt lgkmcnt(0)
    v_pk_add_f32 v[92:93], v[92:93], v[108:109]
    v_pk_add_f32 v[94:95], v[94:95], v[110:111]
    v_pk_add_f32 v[92:93], v[92:93], v[124:125]
    v_pk_add_f32 v[94:95], v[94:95], v[126:127]
    v_pk_add_f32 v[134:135], v[134:135], v[86:87]
    v_pk_add_f32 v[128:129], v[128:129], v[80:81]
    v_cmp_le_f32 vcc, s4, v135
    v_cmp_ge_f32 s[58:59], s5, v135
    v_pk_add_f32 v[130:131], v[130:131], v[82:83]
    v_pk_add_f32 v[132:133], v[132:133], v[84:85]
    v_pk_add_f32 v[136:137], v[136:137], v[88:89]
    v_pk_add_f32 v[138:139], v[138:139], v[90:91]
    v_pk_add_f32 v[140:141], v[140:141], v[92:93]
    v_pk_add_f32 v[142:143], v[142:143], v[94:95]
    s_and_b64 s[58:59], s[58:59], vcc
    s_cmp_eq_u64 s[58:59], -1
    s_cbranch_scc0 sequential_preLN__softmax_full_mha__glu_gated_glu__prompt_kernel_fb
sequential_preLN__softmax_full_mha__glu_gated_glu__prompt_kernel_norm:
    s_nop 0
    v_rcp_f32 v4, v135
    s_mov_b32 s4, 0xffff
    v_pk_mul_f32 v[128:129], v[128:129], v[4:5] op_sel_hi:[1,0]
    v_pk_mul_f32 v[130:131], v[130:131], v[4:5] op_sel_hi:[1,0]
    v_pk_mul_f32 v[132:133], v[132:133], v[4:5] op_sel_hi:[1,0]
    v_pk_mul_f32 v[134:135], v[134:135], v[4:5] op_sel_hi:[1,0]
    v_cvt_pk_bf16_f32 v48, v128, v129
    v_cvt_pk_bf16_f32 v49, v130, v131
    v_cvt_pk_bf16_f32 v50, v132, v133
    v_cvt_pk_bf16_f32 v51, v134, v135
    v_bfi_b32 v51, s4, v51, v30
    buffer_store_dwordx4 v[48:51], v29, s[32:35], s62 offen offset:0 sc1
    v_pk_mul_f32 v[136:137], v[136:137], v[4:5] op_sel_hi:[1,0]
    v_pk_mul_f32 v[138:139], v[138:139], v[4:5] op_sel_hi:[1,0]
    v_pk_mul_f32 v[140:141], v[140:141], v[4:5] op_sel_hi:[1,0]
    v_pk_mul_f32 v[142:143], v[142:143], v[4:5] op_sel_hi:[1,0]
    v_cvt_pk_bf16_f32 v52, v136, v137
    v_cvt_pk_bf16_f32 v53, v138, v139
    v_cvt_pk_bf16_f32 v54, v140, v141
    v_cvt_pk_bf16_f32 v55, v142, v143
    v_bfi_b32 v55, s4, v55, v30
    buffer_store_dwordx4 v[52:55], v29, s[32:35], s62 offen offset:512 sc1
    s_cmp_ge_u32 s7, 28
    s_cbranch_scc1 sequential_preLN__softmax_full_mha__glu_gated_glu__prompt_kernel_spare
    v_mov_b32 v24, v248
    v_lshrrev_b32 v26, 3, v1
    v_and_b32 v27, 6, v26
    v_and_b32 v12, 7, v1
    v_xor_b32 v27, v27, v12
    v_mul_u32_u24 v26, 896, v26
    v_lshl_add_u32 v12, v27, 4, v26
    v_add_u32 v13, 6144, v12
    v_add_u32 v14, 12288, v12
    v_add_u32 v15, 18432, v12
    s_lshr_b32 s4, s49, 1
    s_lshl_b32 s4, s4, 7
    s_mul_i32 s50, s3, 401408
    s_add_u32 s50, s50, s4
    s_mul_i32 s51, s3, 12288
    s_add_u32 s51, s51, 65536
    s_add_u32 m0, s51, 49152
    s_nop 0
    buffer_load_dwordx4 v12, s[24:27], s50 offen offset:0 lds
    ds_read_b64_tr_b16 v[128:129], v20 offset:0
    ds_read_b64_tr_b16 v[130:131], v20 offset:512
    ds_read_b64_tr_b16 v[132:133], v21 offset:0
    ds_read_b64_tr_b16 v[134:135], v21 offset:512
    ds_read_b64_tr_b16 v[136:137], v22 offset:0
    buffer_load_dwordx4 v13, s[24:27], s50 offen offset:1024 lds
    ds_read_b64_tr_b16 v[138:139], v22 offset:512
    ds_read_b64_tr_b16 v[140:141], v23 offset:0
    ds_read_b64_tr_b16 v[142:143], v23 offset:512
    ds_read_b64_tr_b16 v[144:145], v23 offset:3584
    ds_read_b64_tr_b16 v[146:147], v20 offset:4096
    buffer_load_dwordx4 v14, s[24:27], s50 offen offset:2048 lds
    ds_read_b64_tr_b16 v[148:149], v20 offset:3584
    ds_read_b64_tr_b16 v[150:151], v21 offset:4096
    ds_read_b64_tr_b16 v[152:153], v21 offset:3584
    ds_read_b64_tr_b16 v[154:155], v22 offset:4096
    ds_read_b64_tr_b16 v[156:157], v22 offset:3584
    buffer_load_dwordx4 v15, s[24:27], s50 offen offset:3072 lds
    s_add_u32 s50, s50, 28672
    ds_read_b64_tr_b16 v[158:159], v23 offset:4096
    s_waitcnt vmcnt(6)
    v_permlane16_swap_b32 v240, v242
    v_permlane16_swap_b32 v241, v243
    v_permlane16_swap_b32 v244, v246
    v_permlane16_swap_b32 v245, v247
    v_lshlrev_b32 v32, 16, v240
    v_and_b32 v33, 0xffff0000, v240
    v_lshlrev_b32 v34, 16, v241
    s_add_u32 m0, s51, 53248
    s_nop 0
    buffer_load_dwordx4 v12, s[24:27], s50 offen offset:0 lds
    v_and_b32 v35, 0xffff0000, v241
    v_lshlrev_b32 v36, 16, v242
    v_and_b32 v37, 0xffff0000, v242
    v_lshlrev_b32 v38, 16, v243
    v_and_b32 v39, 0xffff0000, v243
    v_lshlrev_b32 v40, 16, v244
    v_and_b32 v41, 0xffff0000, v244
    v_lshlrev_b32 v42, 16, v245
    v_and_b32 v43, 0xffff0000, v245
    v_lshlrev_b32 v44, 16, v246
    v_and_b32 v45, 0xffff0000, v246
    buffer_load_dwordx4 v13, s[24:27], s50 offen offset:1024 lds
    v_lshlrev_b32 v46, 16, v247
    v_and_b32 v47, 0xffff0000, v247
    s_sub_u32 s5, s13, s12
    s_mul_i32 s5, s5, 7
    s_ashr_i32 s5, s5, 8
    v_add_u32 v20, s5, v20
    v_add_u32 v21, s5, v21
    v_add_u32 v22, s5, v22
    v_add_u32 v23, s5, v23
    ds_read_b64_tr_b16 v[160:161], v23 offset:0
    buffer_load_dwordx4 v14, s[24:27], s50 offen offset:2048 lds
    ds_read_b64_tr_b16 v[162:163], v23 offset:512
    ds_read_b64_tr_b16 v[164:165], v20 offset:0
    ds_read_b64_tr_b16 v[166:167], v20 offset:512
    ds_read_b64_tr_b16 v[168:169], v21 offset:0
    ds_read_b64_tr_b16 v[170:171], v21 offset:512
    buffer_load_dwordx4 v15, s[24:27], s50 offen offset:3072 lds
    s_add_u32 s50, s50, 28672
    ds_read_b64_tr_b16 v[172:173], v22 offset:0
    ds_read_b64_tr_b16 v[174:175], v22 offset:512
    ds_read_b64_tr_b16 v[176:177], v22 offset:3584
    ds_read_b64_tr_b16 v[178:179], v23 offset:4096
    ds_read_b64_tr_b16 v[180:181], v23 offset:3584
    ds_read_b64_tr_b16 v[182:183], v20 offset:4096
    ds_read_b64_tr_b16 v[184:185], v20 offset:3584
    ds_read_b64_tr_b16 v[186:187], v21 offset:4096
    ds_read_b64_tr_b16 v[188:189], v21 offset:3584
    ds_read_b64_tr_b16 v[190:191], v22 offset:4096
    s_sub_u32 s5, s14, s13
    s_mul_i32 s5, s5, 7
    s_ashr_i32 s5, s5, 8
    v_add_u32 v20, s5, v20
    v_add_u32 v21, s5, v21
    v_add_u32 v22, s5, v22
    v_add_u32 v23, s5, v23
    ds_read_b64_tr_b16 v[192:193], v22 offset:0
    ds_read_b64_tr_b16 v[194:195], v22 offset:512
    ds_read_b64_tr_b16 v[196:197], v23 offset:0
    ds_read_b64_tr_b16 v[198:199], v23 offset:512
    ds_read_b64_tr_b16 v[200:201], v20 offset:0
    ds_read_b64_tr_b16 v[202:203], v20 offset:512
    ds_read_b64_tr_b16 v[204:205], v21 offset:0
    ds_read_b64_tr_b16 v[206:207], v21 offset:512
    ds_read_b64_tr_b16 v[208:209], v21 offset:3584
    ds_read_b64_tr_b16 v[210:211], v22 offset:4096
    ds_read_b64_tr_b16 v[212:213], v22 offset:3584
    ds_read_b64_tr_b16 v[214:215], v23 offset:4096
    ds_read_b64_tr_b16 v[216:217], v23 offset:3584
    ds_read_b64_tr_b16 v[218:219], v20 offset:4096
    ds_read_b64_tr_b16 v[220:221], v20 offset:3584
    ds_read_b64_tr_b16 v[222:223], v21 offset:4096
    s_sub_u32 s5, s15, s14
    s_mul_i32 s5, s5, 7
    s_ashr_i32 s5, s5, 8
    v_add_u32 v20, s5, v20
    v_add_u32 v21, s5, v21
    v_add_u32 v22, s5, v22
    v_add_u32 v23, s5, v23
    ds_read_b64_tr_b16 v[224:225], v21 offset:0
    ds_read_b64_tr_b16 v[226:227], v21 offset:512
    ds_read_b64_tr_b16 v[228:229], v22 offset:0
    ds_read_b64_tr_b16 v[230:231], v22 offset:512
    ds_read_b64_tr_b16 v[232:233], v23 offset:0
    ds_read_b64_tr_b16 v[234:235], v23 offset:512
    ds_read_b64_tr_b16 v[236:237], v20 offset:0
    ds_read_b64_tr_b16 v[238:239], v20 offset:512
    ds_read_b64_tr_b16 v[240:241], v20 offset:3584
    ds_read_b64_tr_b16 v[242:243], v21 offset:4096
    ds_read_b64_tr_b16 v[244:245], v21 offset:3584
    buffer_load_dwordx4 v[64:67], v2, s[32:35], s12 offen offset:0 sc1
    ds_read_b64_tr_b16 v[246:247], v22 offset:4096
    ds_read_b64_tr_b16 v[248:249], v22 offset:3584
    ds_read_b64_tr_b16 v[250:251], v23 offset:4096
    ds_read_b64_tr_b16 v[252:253], v23 offset:3584
    buffer_load_dwordx4 v[68:71], v0, s[32:35], s12 offen offset:0 sc1
    ds_read_b64_tr_b16 v[254:255], v20 offset:4096
    v_mov_b32 v4, 0x3f803f80
    v_accvgpr_write_b32 a240, v4
    v_accvgpr_write_b32 a241, v4
    v_accvgpr_write_b32 a242, v4
    v_accvgpr_write_b32 a243, v4
    s_nop 1
    v_mfma_f32_16x16x32_bf16 v[48:51], a[0:3], a[240:243], 0
    v_lshrrev_b32 v7, 2, v1
    buffer_load_dwordx4 v[72:75], v2, s[32:35], s12 offen offset:1024 sc1
    v_lshlrev_b32 v6, 7, v7
    v_mfma_f32_16x16x32_bf16 v[52:55], a[4:7], a[240:243], 0
    v_and_b32 v7, 3, v1
    v_lshl_add_u32 v6, v7, 3, v6
    v_mfma_f32_16x16x32_bf16 v[56:59], a[8:11], a[240:243], 0
    v_bfe_u32 v7, v1, 3, 2
    v_lshl_add_u32 v6, v7, 5, v6
    v_mfma_f32_16x16x32_bf16 v[60:63], a[12:15], a[240:243], 0
    buffer_load_dwordx4 v[76:79], v0, s[32:35], s12 offen offset:1024 sc1
    s_and_b32 s4, s3, 1
    s_xor_b32 s4, s4, 1
    v_mfma_f32_16x16x32_bf16 v[48:51], a[16:19], a[240:243], v[48:51]
    s_lshl_b32 s4, s4, 6
    v_xor_b32 v6, s4, v6
    v_mfma_f32_16x16x32_bf16 v[52:55], a[20:23], a[240:243], v[52:55]
    v_add_u32 v8, s51, v6
    buffer_load_dwordx4 v[80:83], v2, s[32:35], s13 offen offset:0 sc1
    v_xor_b32 v9, 32, v8
    v_mfma_f32_16x16x32_bf16 v[56:59], a[24:27], a[240:243], v[56:59]
    v_xor_b32 v10, 64, v8
    v_xor_b32 v11, 96, v8
    v_mfma_f32_16x16x32_bf16 v[60:63], a[28:31], a[240:243], v[60:63]
    s_and_b32 s57, s57, 7
    s_mul_i32 s52, s48, 114688
    v_mfma_f32_16x16x32_bf16 v[48:51], a[32:35], a[240:243], v[48:51]
    buffer_load_dwordx4 v[84:87], v0, s[32:35], s13 offen offset:0 sc1
    s_add_u32 s52, s52, s45
    s_add_u32 s52, s52, 0
    v_mfma_f32_16x16x32_bf16 v[52:55], a[36:39], a[240:243], v[52:55]
    s_mul_i32 s53, s48, 458752
    s_add_u32 s53, s53, s45
    v_mfma_f32_16x16x32_bf16 v[56:59], a[40:43], a[240:243], v[56:59]
    s_add_u32 s53, s53, 1048576
    s_mul_i32 s56, s3, 14336
    buffer_load_dwordx4 v[88:91], v2, s[32:35], s13 offen offset:1024 sc1
    v_mfma_f32_16x16x32_bf16 v[60:63], a[44:47], a[240:243], v[60:63]
    s_add_u32 s56, s56, s53
    s_lshl_b32 s58, s49, 2
    v_mfma_f32_16x16x32_bf16 v[48:51], a[48:51], a[240:243], v[48:51]
    s_add_u32 s58, s58, s3
    s_lshl_b32 s4, s58, 10
    v_mfma_f32_16x16x32_bf16 v[52:55], a[52:55], a[240:243], v[52:55]
    buffer_load_dwordx4 v[92:95], v0, s[32:35], s13 offen offset:1024 sc1
    s_add_u32 s53, s53, s4
    s_lshl_b32 s4, s3, 12
    v_mfma_f32_16x16x32_bf16 v[56:59], a[56:59], a[240:243], v[56:59]
    v_add_u32 v6, s4, v2
    v_xor_b32 v7, 4096, v6
    v_mfma_f32_16x16x32_bf16 v[60:63], a[60:63], a[240:243], v[60:63]
    s_mul_i32 s16, s57, 14
    s_and_b32 s4, s49, -2
    buffer_load_dwordx4 v[96:99], v2, s[32:35], s14 offen offset:0 sc1
    v_mfma_f32_16x16x32_bf16 v[48:51], a[64:67], a[240:243], v[48:51]
    s_add_u32 s16, s16, s4
    s_and_b32 s4, s3, 1
    v_mfma_f32_16x16x32_bf16 v[52:55], a[68:71], a[240:243], v[52:55]
    s_add_u32 s16, s16, s4
    s_lshl_b32 s59, s16, 10
    v_mfma_f32_16x16x32_bf16 v[56:59], a[72:75], a[240:243], v[56:59]
    s_add_u32 s59, s59, s52
    buffer_load_dwordx4 v[100:103], v0, s[32:35], s14 offen offset:0 sc1
    s_mul_i32 s4, s48, 14336
    v_mfma_f32_16x16x32_bf16 v[60:63], a[76:79], a[240:243], v[60:63]
    s_add_u32 s4, s4, s45
    s_add_u32 s54, s4, 229376
    v_mfma_f32_16x16x32_bf16 v[48:51], a[80:83], a[240:243], v[48:51]
    s_lshl_b32 s16, s16, 7
    s_add_u32 s16, s16, s54
    v_mfma_f32_16x16x32_bf16 v[52:55], a[84:87], a[240:243], v[52:55]
    buffer_load_dwordx4 v[104:107], v2, s[32:35], s14 offen offset:1024 sc1
    s_add_u32 s62, s59, 57344
    v_mfma_f32_16x16x32_bf16 v[56:59], a[88:91], a[240:243], v[56:59]
    v_mfma_f32_16x16x32_bf16 v[60:63], a[92:95], a[240:243], v[60:63]
    v_mfma_f32_16x16x32_bf16 v[48:51], a[96:99], a[240:243], v[48:51]
    buffer_load_dwordx4 v[108:111], v0, s[32:35], s14 offen offset:1024 sc1
    v_mfma_f32_16x16x32_bf16 v[52:55], a[100:103], a[240:243], v[52:55]
    v_mfma_f32_16x16x32_bf16 v[56:59], a[104:107], a[240:243], v[56:59]
    v_mfma_f32_16x16x32_bf16 v[60:63], a[108:111], a[240:243], v[60:63]
    s_waitcnt vmcnt(20)
    buffer_load_dwordx4 v[112:115], v2, s[32:35], s15 offen offset:0 sc1
    v_mfma_f32_16x16x32_bf16 v[48:51], a[112:115], a[240:243], v[48:51]
    v_mfma_f32_16x16x32_bf16 v[52:55], a[116:119], a[240:243], v[52:55]
    v_mfma_f32_16x16x32_bf16 v[56:59], a[120:123], a[240:243], v[56:59]
    buffer_load_dwordx4 v[116:119], v0, s[32:35], s15 offen offset:0 sc1
    v_mfma_f32_16x16x32_bf16 v[60:63], a[124:127], a[240:243], v[60:63]
    v_mfma_f32_16x16x32_bf16 v[48:51], a[128:131], a[240:243], v[48:51]
    buffer_load_dwordx4 v[120:123], v2, s[32:35], s15 offen offset:1024 sc1
    v_mfma_f32_16x16x32_bf16 v[52:55], a[132:135], a[240:243], v[52:55]
    v_mfma_f32_16x16x32_bf16 v[56:59], a[136:139], a[240:243], v[56:59]
    v_mfma_f32_16x16x32_bf16 v[60:63], a[140:143], a[240:243], v[60:63]
    buffer_load_dwordx4 v[124:127], v0, s[32:35], s15 offen offset:1024 sc1
    v_mfma_f32_16x16x32_bf16 v[48:51], a[144:147], a[240:243], v[48:51]
    v_mfma_f32_16x16x32_bf16 v[52:55], a[148:151], a[240:243], v[52:55]
    v_mfma_f32_16x16x32_bf16 v[56:59], a[152:155], a[240:243], v[56:59]
    v_mfma_f32_16x16x32_bf16 v[60:63], a[156:159], a[240:243], v[60:63]
    v_mfma_f32_16x16x32_bf16 v[48:51], a[160:163], a[240:243], v[48:51]
    v_mfma_f32_16x16x32_bf16 v[52:55], a[164:167], a[240:243], v[52:55]
    v_mfma_f32_16x16x32_bf16 v[56:59], a[168:171], a[240:243], v[56:59]
    v_mfma_f32_16x16x32_bf16 v[60:63], a[172:175], a[240:243], v[60:63]
    s_mov_b32 s5, 0xffff
    s_waitcnt vmcnt(28) lgkmcnt(0)
    s_barrier
    s_cmp_eq_u32 s38, 0
    s_cbranch_scc1 sequential_preLN__softmax_full_mha__glu_gated_glu__prompt_kernel_sb6a
    buffer_store_dword v30, v31, s[36:39], s60 offen offset:0
sequential_preLN__softmax_full_mha__glu_gated_glu__prompt_kernel_sb6b:
    s_waitcnt vmcnt(13)
    v_xor_b32 v67, s61, v67
    v_xor_b32 v71, s61, v71
    v_xor_b32 v75, s61, v75
    v_xor_b32 v79, s61, v79
    v_or3_b32 v4, v67, v71, v75
    v_or_b32 v4, v4, v79
    v_cmp_lt_u32 vcc, s5, v4
    s_cbranch_vccnz sequential_preLN__softmax_full_mha__glu_gated_glu__prompt_kernel_or0
sequential_preLN__softmax_full_mha__glu_gated_glu__prompt_kernel_od0:
    v_mfma_f32_16x16x32_bf16 a[224:227], v[128:131], v[64:67], 0
    v_lshrrev_b32 v22, 5, v1
    ds_read_b64_tr_b16 a[182:183], v17 offset:2048
    v_mfma_f32_16x16x32_bf16 a[228:231], v[132:135], v[64:67], 0
    v_mfma_f32_16x16x32_bf16 a[232:235], v[128:131], v[72:75], 0
    ds_read_b64_tr_b16 a[184:185], v16 offset:4096
    v_mfma_f32_16x16x32_bf16 a[236:239], v[132:135], v[72:75], 0
    v_mfma_f32_16x16x32_bf16 a[224:227], v[144:147], v[68:71], a[224:227]
    v_mul_u32_u24 v21, 7168, v22
    ds_read_b64_tr_b16 a[186:187], v16 offset:6144
    v_mfma_f32_16x16x32_bf16 a[228:231], v[148:151], v[68:71], a[228:231]
    v_mfma_f32_16x16x32_bf16 a[232:235], v[144:147], v[76:79], a[232:235]
    ds_read_b64_tr_b16 a[188:189], v17 offset:4096
    v_mfma_f32_16x16x32_bf16 a[236:239], v[148:151], v[76:79], a[236:239]
    v_mfma_f32_16x16x32_bf16 v[32:35], v[136:139], v[64:67], v[32:35]
    v_and_b32 v22, 31, v1
    v_mfma_f32_16x16x32_bf16 v[36:39], v[140:143], v[64:67], v[36:39]
    ds_read_b64_tr_b16 a[190:191], v17 offset:6144
    v_mfma_f32_16x16x32_bf16 v[40:43], v[136:139], v[72:75], v[40:43]
    v_mfma_f32_16x16x32_bf16 v[44:47], v[140:143], v[72:75], v[44:47]
    ds_read_b64_tr_b16 a[192:193], v16 offset:16384
    v_mfma_f32_16x16x32_bf16 v[32:35], v[152:155], v[68:71], v[32:35]
    s_waitcnt vmcnt(9)
    v_xor_b32 v83, s61, v83
    v_xor_b32 v87, s61, v87
    v_xor_b32 v91, s61, v91
    v_mfma_f32_16x16x32_bf16 v[36:39], v[156:159], v[68:71], v[36:39]
    v_xor_b32 v95, s61, v95
    v_or3_b32 v4, v83, v87, v91
    v_or_b32 v4, v4, v95
    v_mfma_f32_16x16x32_bf16 v[40:43], v[152:155], v[76:79], v[40:43]
    v_cmp_lt_u32 vcc, s5, v4
    v_lshl_add_u32 v21, v22, 2, v21
    v_mfma_f32_16x16x32_bf16 v[44:47], v[156:159], v[76:79], v[44:47]
    s_cbranch_vccnz sequential_preLN__softmax_full_mha__glu_gated_glu__prompt_kernel_or1
sequential_preLN__softmax_full_mha__glu_gated_glu__prompt_kernel_od1:
    ds_read_b64_tr_b16 a[194:195], v16 offset:18432
    ds_read_b64_tr_b16 a[196:197], v17 offset:16384
    v_mfma_f32_16x16x32_bf16 a[224:227], v[160:163], v[80:83], a[224:227]
    v_mfma_f32_16x16x32_bf16 a[228:231], v[164:167], v[80:83], a[228:231]
    v_and_b32 v22, 31, v1
    v_mfma_f32_16x16x32_bf16 a[232:235], v[160:163], v[88:91], a[232:235]
    ds_read_b64_tr_b16 a[198:199], v17 offset:18432
    v_mfma_f32_16x16x32_bf16 a[236:239], v[164:167], v[88:91], a[236:239]
    v_mfma_f32_16x16x32_bf16 a[224:227], v[176:179], v[84:87], a[224:227]
    ds_read_b64_tr_b16 a[200:201], v16 offset:20480
    v_mfma_f32_16x16x32_bf16 a[228:231], v[180:183], v[84:87], a[228:231]
    v_mfma_f32_16x16x32_bf16 a[232:235], v[176:179], v[92:95], a[232:235]
    v_lshlrev_b32 v20, 2, v22
    ds_read_b64_tr_b16 a[202:203], v16 offset:22528
    v_mfma_f32_16x16x32_bf16 a[236:239], v[180:183], v[92:95], a[236:239]
    v_mfma_f32_16x16x32_bf16 v[32:35], v[168:171], v[80:83], v[32:35]
    v_mfma_f32_16x16x32_bf16 v[36:39], v[172:175], v[80:83], v[36:39]
    ds_read_b64_tr_b16 a[204:205], v17 offset:20480
    v_mfma_f32_16x16x32_bf16 v[40:43], v[168:171], v[88:91], v[40:43]
    v_min_u32 v22, 55, v1
    v_mfma_f32_16x16x32_bf16 v[44:47], v[172:175], v[88:91], v[44:47]
    ds_read_b64_tr_b16 a[206:207], v17 offset:22528
    v_mfma_f32_16x16x32_bf16 v[32:35], v[184:187], v[84:87], v[32:35]
    s_waitcnt vmcnt(5)
    v_xor_b32 v99, s61, v99
    v_xor_b32 v103, s61, v103
    v_xor_b32 v107, s61, v107
    v_mfma_f32_16x16x32_bf16 v[36:39], v[188:191], v[84:87], v[36:39]
    v_xor_b32 v111, s61, v111
    v_or3_b32 v4, v99, v103, v107
    v_or_b32 v4, v4, v111
    v_mfma_f32_16x16x32_bf16 v[40:43], v[184:187], v[92:95], v[40:43]
    v_cmp_lt_u32 vcc, s5, v4
    ds_read_b64_tr_b16 a[208:209], v16 offset:32768
    v_mfma_f32_16x16x32_bf16 v[44:47], v[188:191], v[92:95], v[44:47]
    s_cbranch_vccnz sequential_preLN__softmax_full_mha__glu_gated_glu__prompt_kernel_or2
sequential_preLN__softmax_full_mha__glu_gated_glu__prompt_kernel_od2:
    v_lshlrev_b32 v22, 2, v22
    ds_read_b64_tr_b16 a[210:211], v16 offset:34816
    v_mfma_f32_16x16x32_bf16 a[224:227], v[192:195], v[96:99], a[224:227]
    v_mfma_f32_16x16x32_bf16 a[228:231], v[196:199], v[96:99], a[228:231]
    v_mfma_f32_16x16x32_bf16 a[232:235], v[192:195], v[104:107], a[232:235]
    ds_read_b64_tr_b16 a[212:213], v17 offset:32768
    v_mfma_f32_16x16x32_bf16 a[236:239], v[196:199], v[104:107], a[236:239]
    s_add_u32 s4, s45, 819840
    v_mfma_f32_16x16x32_bf16 a[224:227], v[208:211], v[100:103], a[224:227]
    s_waitcnt vmcnt(1)
    v_xor_b32 v115, s61, v115
    v_xor_b32 v119, s61, v119
    v_xor_b32 v123, s61, v123
    v_mfma_f32_16x16x32_bf16 a[228:231], v[212:215], v[100:103], a[228:231]
    v_xor_b32 v127, s61, v127
    v_or3_b32 v4, v115, v119, v123
    v_or_b32 v4, v4, v127
    v_mfma_f32_16x16x32_bf16 a[232:235], v[208:211], v[108:111], a[232:235]
    v_cmp_lt_u32 vcc, s5, v4
    ds_read_b64_tr_b16 a[214:215], v17 offset:34816
    v_mfma_f32_16x16x32_bf16 a[236:239], v[212:215], v[108:111], a[236:239]
    s_cbranch_vccnz sequential_preLN__softmax_full_mha__glu_gated_glu__prompt_kernel_or3
sequential_preLN__softmax_full_mha__glu_gated_glu__prompt_kernel_od3:
    ds_read_b64_tr_b16 a[216:217], v16 offset:36864
    v_mfma_f32_16x16x32_bf16 a[224:227], v[224:227], v[112:115], a[224:227]
    buffer_load_dword v23, v20, s[32:35], s4 offen offset:0 sc1
    v_mfma_f32_16x16x32_bf16 a[228:231], v[228:231], v[112:115], a[228:231]
    ds_read_b64_tr_b16 a[218:219], v16 offset:38912
    v_mfma_f32_16x16x32_bf16 a[232:235], v[224:227], v[120:123], a[232:235]
    v_mfma_f32_16x16x32_bf16 a[236:239], v[228:231], v[120:123], a[236:239]
    s_add_u32 m0, s51, 57344
    s_nop 0
    buffer_load_dwordx4 v12, s[24:27], s50 offen offset:0 lds
    ds_read_b64_tr_b16 a[220:221], v17 offset:36864
    v_mfma_f32_16x16x32_bf16 a[224:227], v[240:243], v[116:119], a[224:227]
    v_mfma_f32_16x16x32_bf16 a[228:231], v[244:247], v[116:119], a[228:231]
    ds_read_b64_tr_b16 a[222:223], v17 offset:38912
    v_mfma_f32_16x16x32_bf16 a[232:235], v[240:243], v[124:127], a[232:235]
    buffer_load_dwordx4 v13, s[24:27], s50 offen offset:1024 lds
    v_mfma_f32_16x16x32_bf16 a[236:239], v[244:247], v[124:127], a[236:239]
    v_mfma_f32_16x16x32_bf16 v[32:35], v[200:203], v[96:99], v[32:35]
    v_mfma_f32_16x16x32_bf16 v[36:39], v[204:207], v[96:99], v[36:39]
    s_nop 0
    ds_write_b128 v6, a[224:227] offset:0
    v_mfma_f32_16x16x32_bf16 v[40:43], v[200:203], v[104:107], v[40:43]
    ds_write_b128 v6, a[228:231] offset:1024
    buffer_load_dwordx4 v14, s[24:27], s50 offen offset:2048 lds
    v_mfma_f32_16x16x32_bf16 v[44:47], v[204:207], v[104:107], v[44:47]
    ds_write_b128 v6, a[232:235] offset:2048
    v_mfma_f32_16x16x32_bf16 v[32:35], v[216:219], v[100:103], v[32:35]
    ds_write_b128 v6, a[236:239] offset:3072
    v_mfma_f32_16x16x32_bf16 v[36:39], v[220:223], v[100:103], v[36:39]
    buffer_load_dwordx4 v15, s[24:27], s50 offen offset:3072 lds
    v_mfma_f32_16x16x32_bf16 v[40:43], v[216:219], v[108:111], v[40:43]
    v_mfma_f32_16x16x32_bf16 v[44:47], v[220:223], v[108:111], v[44:47]
    v_mfma_f32_16x16x32_bf16 v[32:35], v[232:235], v[112:115], v[32:35]
    s_add_u32 s50, s50, 28672
    v_mfma_f32_16x16x32_bf16 v[36:39], v[236:239], v[112:115], v[36:39]
    s_waitcnt lgkmcnt(0)
    s_barrier
    v_mfma_f32_16x16x32_bf16 v[40:43], v[232:235], v[120:123], v[40:43]
    ds_read_b128 v[64:67], v7 offset:0
    s_add_u32 m0, s51, 0
    v_mfma_f32_16x16x32_bf16 v[44:47], v[236:239], v[120:123], v[44:47]
    ds_read_b128 v[68:71], v7 offset:1024
    buffer_load_dwordx4 v12, s[24:27], s50 offen offset:0 lds
    v_mfma_f32_16x16x32_bf16 v[32:35], v[248:251], v[116:119], v[32:35]
    ds_read_b128 v[72:75], v7 offset:2048
    buffer_load_dwordx4 v13, s[24:27], s50 offen offset:1024 lds
    v_mfma_f32_16x16x32_bf16 v[36:39], v[252:255], v[116:119], v[36:39]
    ds_read_b128 v[76:79], v7 offset:3072
    buffer_load_dwordx4 v14, s[24:27], s50 offen offset:2048 lds
    v_mfma_f32_16x16x32_bf16 v[40:43], v[248:251], v[124:127], v[40:43]
    buffer_load_dwordx4 v15, s[24:27], s50 offen offset:3072 lds
    v_mfma_f32_16x16x32_bf16 v[44:47], v[252:255], v[124:127], v[44:47]
    s_add_u32 s50, s50, 28672
    s_waitcnt vmcnt(8)
    v_cmp_ne_u32 vcc, s44, v23
    s_cbranch_vccnz sequential_preLN__softmax_full_mha__glu_gated_glu__prompt_kernel_fbr
sequential_preLN__softmax_full_mha__glu_gated_glu__prompt_kernel_fbd:
    s_waitcnt lgkmcnt(2)
    v_pk_add_f32 v[32:33], v[32:33], v[64:65]
    v_pk_add_f32 v[34:35], v[34:35], v[66:67]
    v_pk_add_f32 v[36:37], v[36:37], v[68:69]
    v_pk_add_f32 v[38:39], v[38:39], v[70:71]
    v_cvt_pk_bf16_f32 v80, v32, v33
    v_cvt_pk_bf16_f32 v81, v34, v35
    v_cvt_pk_bf16_f32 v82, v36, v37
    v_cvt_pk_bf16_f32 v83, v38, v39
    s_cmp_eq_u32 s38, 0
    s_cbranch_scc1 sequential_preLN__softmax_full_mha__glu_gated_glu__prompt_kernel_sb7a
    buffer_store_dwordx4 v[80:83], v2, s[36:39], s59 offen offset:0
sequential_preLN__softmax_full_mha__glu_gated_glu__prompt_kernel_sb7b:
    s_waitcnt lgkmcnt(0)
    v_pk_add_f32 v[40:41], v[40:41], v[72:73]
    v_pk_add_f32 v[42:43], v[42:43], v[74:75]
    v_pk_add_f32 v[44:45], v[44:45], v[76:77]
sequential_preLN__softmax_full_mha__glu_gated_glu__prompt_kernel_pg5:
    s_cbranch_execz sequential_preLN__softmax_full_mha__glu_gated_glu__prompt_kernel_tb5
    v_pk_add_f32 v[46:47], v[46:47], v[78:79]
    v_cvt_pk_bf16_f32 v84, v40, v41
    v_cvt_pk_bf16_f32 v85, v42, v43
    v_cvt_pk_bf16_f32 v86, v44, v45
    v_cvt_pk_bf16_f32 v87, v46, v47
    s_cmp_eq_u32 s38, 0
    s_cbranch_scc1 sequential_preLN__softmax_full_mha__glu_gated_glu__prompt_kernel_sb8a
    buffer_store_dwordx4 v[84:87], v2, s[36:39], s62 offen offset:0
sequential_preLN__softmax_full_mha__glu_gated_glu__prompt_kernel_sb8b:
    v_pk_add_f32 v[64:65], v[32:33], v[34:35]
    v_pk_mul_f32 v[66:67], v[32:33], v[32:33]
    v_pk_fma_f32 v[66:67], v[34:35], v[34:35], v[66:67]
    v_pk_add_f32 v[64:65], v[64:65], v[36:37]
    v_pk_fma_f32 v[66:67], v[36:37], v[36:37], v[66:67]
    v_pk_add_f32 v[64:65], v[64:65], v[38:39]
    v_pk_fma_f32 v[66:67], v[38:39], v[38:39], v[66:67]
    v_pk_add_f32 v[68:69], v[40:41], v[42:43]
    v_pk_mul_f32 v[70:71], v[40:41], v[40:41]
    v_pk_fma_f32 v[70:71], v[42:43], v[42:43], v[70:71]
    v_pk_add_f32 v[68:69], v[68:69], v[44:45]
    v_pk_fma_f32 v[70:71], v[44:45], v[44:45], v[70:71]
    v_pk_add_f32 v[68:69], v[68:69], v[46:47]
    v_pk_fma_f32 v[70:71], v[46:47], v[46:47], v[70:71]
    v_add_f32 v64, v64, v65
    v_add_f32 v66, v66, v67
    v_add_f32 v68, v68, v69
    v_add_f32 v70, v70, v71
    s_nop 0
    v_permlane32_swap_b32 v64, v68
    v_permlane32_swap_b32 v66, v70
    v_add_f32 v4, v64, v68
    v_add_f32 v5, v66, v70
    s_lshl_b32 s4, s48, 8
    s_add_u32 s4, s4, s45
    v_permlane16_swap_b32 v4, v5
    v_add_f32 v4, v4, v5
    s_cmp_eq_u32 s38, 0
    s_cbranch_scc1 sequential_preLN__softmax_full_mha__glu_gated_glu__prompt_kernel_sb9a
    buffer_store_dword v4, v21, s[36:39], s16 offen offset:0
sequential_preLN__softmax_full_mha__glu_gated_glu__prompt_kernel_sb9b:
    s_add_u32 s59, s4, 819968
    s_lshl_b32 s58, s58, 2
    s_add_u32 s5, s59, s58
    v_mfma_f32_16x16x32_bf16 v[48:51], a[176:179], a[240:243], v[48:51]
    v_lshrrev_b32 v4, 5, v1
    v_mul_u32_u24 v6, 1792, v4
    v_mfma_f32_16x16x32_bf16 v[52:55], a[180:183], a[240:243], v[52:55]
    v_and_b32 v4, 31, v1
    s_waitcnt vmcnt(33)
    v_mfma_f32_16x16x32_bf16 v[56:59], a[184:187], a[240:243], v[56:59]
    v_lshl_add_u32 v6, v4, 2, v6
    ds_read_b64_tr_b16 v[128:129], v8 offset:49152
    v_mfma_f32_16x16x32_bf16 v[60:63], a[188:191], a[240:243], v[60:63]
    v_and_b32 v4, 15, v1
    v_lshlrev_b32 v20, 4, v4
    v_mfma_f32_16x16x32_bf16 v[48:51], a[192:195], a[240:243], v[48:51]
    v_add_u32 v20, 57344, v20
    ds_read_b64_tr_b16 v[130:131], v8 offset:51200
    v_mfma_f32_16x16x32_bf16 v[52:55], a[196:199], a[240:243], v[52:55]
    s_lshl_b32 s4, s3, 9
    v_lshrrev_b32 v4, 5, v1
    ds_read_b64_tr_b16 v[132:133], v9 offset:49152
    v_mfma_f32_16x16x32_bf16 v[56:59], a[200:203], a[240:243], v[56:59]
    v_lshlrev_b32 v7, 8, v4
    ds_read_b64_tr_b16 v[134:135], v9 offset:51200
    v_mfma_f32_16x16x32_bf16 v[60:63], a[204:207], a[240:243], v[60:63]
    v_add_u32 v7, s4, v7
    v_add_u32 v7, v7, v20
    v_mfma_f32_16x16x32_bf16 v[48:51], a[208:211], a[240:243], v[48:51]
    s_xor_b32 s4, s3, 3
    s_mul_i32 s4, s4, 6144
    s_add_u32 s4, s4, 0
    v_mfma_f32_16x16x32_bf16 v[52:55], a[212:215], a[240:243], v[52:55]
    v_add_u32 v24, s4, v2
    s_xor_b32 s4, s3, 2
    v_mfma_f32_16x16x32_bf16 v[56:59], a[216:219], a[240:243], v[56:59]
    s_mul_i32 s4, s4, 6144
    s_add_u32 s4, s4, 2048
    v_add_u32 v25, s4, v2
    v_mfma_f32_16x16x32_bf16 v[60:63], a[220:223], a[240:243], v[60:63]
    s_xor_b32 s4, s3, 1
    s_mul_i32 s4, s4, 6144
    s_add_u32 s4, s4, 4096
    v_add_u32 v26, s4, v2
    s_mul_i32 s4, s3, 6144
    v_add_u32 v27, s4, v2
    s_cmp_lt_u32 s49, 7
    s_cselect_b32 s18, 28672, 0
    s_cselect_b32 s4, 1, 0
    s_xor_b32 s4, s4, s3
    s_add_u32 s52, s52, s18
    s_lshl_b32 s18, s18, 1
    s_mul_i32 s4, s4, 3584
    s_add_u32 s54, s54, s4
    s_lshl_b32 s4, s48, 9
    s_add_u32 s4, s4, s45
    s_add_u32 s17, s4, 820480
    s_add_u32 s58, s58, s17
    s_mul_i32 s16, s3, 56
    s_add_u32 s16, s16, s17
    s_mul_i32 s62, s48, -344064
    s_add_u32 s62, s62, -1392640
    s_and_b32 s4, s57, 1
    s_mul_i32 s4, s4, 57344
    s_add_u32 s12, s56, s4
    s_add_u32 s13, s12, 114688
    s_add_u32 s14, s12, 229376
    s_add_u32 s15, s14, s62
    s_add_u32 s15, s15, 114688
    s_add_u32 s62, s62, 57344
    ds_read_b64_tr_b16 v[136:137], v10 offset:49152
    ds_read_b64_tr_b16 v[138:139], v10 offset:51200
    ds_read_b64_tr_b16 v[140:141], v11 offset:49152
    s_waitcnt vmcnt(0)
    s_cmp_eq_u32 s38, 0
    s_cbranch_scc1 sequential_preLN__softmax_full_mha__glu_gated_glu__prompt_kernel_sb10a
    buffer_store_dword v30, v31, s[36:39], s5 offen offset:0
sequential_preLN__softmax_full_mha__glu_gated_glu__prompt_kernel_sb10b:
    ds_read_b64_tr_b16 v[142:143], v11 offset:51200
    s_waitcnt vmcnt(30)
    ds_read_b64_tr_b16 v[144:145], v8 offset:53248
    ds_read_b64_tr_b16 v[146:147], v8 offset:55296
    ds_read_b64_tr_b16 v[148:149], v9 offset:53248
    ds_read_b64_tr_b16 v[150:151], v9 offset:55296
    ds_read_b64_tr_b16 v[152:153], v10 offset:53248
    ds_read_b64_tr_b16 v[154:155], v10 offset:55296
    ds_read_b64_tr_b16 v[156:157], v11 offset:53248
    ds_read_b64_tr_b16 v[158:159], v11 offset:55296
    buffer_load_dword v23, v22, s[32:35], s59 offen offset:0 sc1
    s_waitcnt vmcnt(9)
    ds_read_b64_tr_b16 v[160:161], v8 offset:57344
    ds_read_b64_tr_b16 v[162:163], v8 offset:59392
    ds_read_b64_tr_b16 v[164:165], v9 offset:57344
    ds_read_b64_tr_b16 v[166:167], v9 offset:59392
    ds_read_b64_tr_b16 v[168:169], v10 offset:57344
    ds_read_b64_tr_b16 v[170:171], v10 offset:59392
    ds_read_b64_tr_b16 v[172:173], v11 offset:57344
    ds_read_b64_tr_b16 v[174:175], v11 offset:59392
    s_waitcnt vmcnt(5)
    ds_read_b64_tr_b16 v[176:177], v8 offset:0
    ds_read_b64_tr_b16 v[178:179], v8 offset:2048
    ds_read_b64_tr_b16 v[180:181], v9 offset:0
    ds_read_b64_tr_b16 v[182:183], v9 offset:2048
    ds_read_b64_tr_b16 v[184:185], v10 offset:0
    ds_read_b64_tr_b16 v[186:187], v10 offset:2048
    ds_read_b64_tr_b16 v[188:189], v11 offset:0
    ds_read_b64_tr_b16 v[190:191], v11 offset:2048
    s_mov_b32 s63, 65536
    s_waitcnt vmcnt(0)
sequential_preLN__softmax_full_mha__glu_gated_glu__prompt_kernel_fcc:
    v_cmp_ne_u32 vcc, s44, v23
    s_cbranch_vccz sequential_preLN__softmax_full_mha__glu_gated_glu__prompt_kernel_fcd
    buffer_load_dword v23, v22, s[32:35], s59 offen offset:0 sc1
    s_sub_u32 s63, s63, 1
    s_waitcnt vmcnt(0)
    s_cbranch_scc0 sequential_preLN__softmax_full_mha__glu_gated_glu__prompt_kernel_fcc
sequential_preLN__softmax_full_mha__glu_gated_glu__prompt_kernel_fcd:
    s_lshl_b32 s4, s3, 10
    s_add_u32 s5, s52, s4
    s_mov_b32 m0, s4
    s_nop 0
    buffer_load_dwordx4 v2, s[32:35], s5 offen sc1 lds
    s_add_u32 m0, m0, 4096
    s_add_u32 s5, s5, 4096
    buffer_load_dwordx4 v2, s[32:35], s5 offen sc1 lds
    s_add_u32 m0, m0, 4096
    s_add_u32 s5, s5, 4096
    buffer_load_dwordx4 v2, s[32:35], s5 offen sc1 lds
    s_add_u32 m0, m0, 4096
    s_add_u32 s5, s5, 4096
    buffer_load_dwordx4 v2, s[32:35], s5 offen sc1 lds
    s_add_u32 m0, m0, 4096
    s_add_u32 s5, s5, 4096
    buffer_load_dword v80, v6, s[32:35], s54 offen offset:0 sc1
    buffer_load_dword v81, v6, s[32:35], s54 offen offset:128 sc1
    buffer_load_dword v82, v6, s[32:35], s54 offen offset:256 sc1
    buffer_load_dword v83, v6, s[32:35], s54 offen offset:384 sc1
    buffer_load_dword v84, v6, s[32:35], s54 offen offset:512 sc1
    buffer_load_dword v85, v6, s[32:35], s54 offen offset:640 sc1
    buffer_load_dword v86, v6, s[32:35], s54 offen offset:768 sc1
    buffer_load_dword v87, v6, s[32:35], s54 offen offset:896 sc1
    buffer_load_dword v88, v6, s[32:35], s54 offen offset:1024 sc1
    buffer_load_dword v89, v6, s[32:35], s54 offen offset:1152 sc1
    buffer_load_dword v90, v6, s[32:35], s54 offen offset:1280 sc1
    buffer_load_dword v91, v6, s[32:35], s54 offen offset:1408 sc1
    buffer_load_dword v92, v6, s[32:35], s54 offen offset:1536 sc1
    buffer_load_dword v93, v6, s[32:35], s54 offen offset:1664 sc1
    buffer_load_dwordx4 v2, s[32:35], s5 offen sc1 lds
    s_add_u32 m0, m0, 4096
    s_add_u32 s5, s5, 4096
    buffer_load_dwordx4 v2, s[32:35], s5 offen sc1 lds
    s_add_u32 m0, m0, 4096
    s_add_u32 s5, s5, 4096
    buffer_load_dwordx4 v2, s[32:35], s5 offen sc1 lds
    s_mul_i32 s54, s3, 7168
    s_add_u32 s52, s52, s54
    v_min_u32 v21, 13, v1
    v_lshlrev_b32 v21, 2, v21
    s_waitcnt vmcnt(17)
    s_barrier
    ds_read_b128 v[96:99], v2 offset:0
    ds_read_b128 v[100:103], v2 offset:1024
    ds_read_b128 v[104:107], v2 offset:2048
    ds_read_b128 v[108:111], v2 offset:3072
    s_waitcnt lgkmcnt(3)
    v_mfma_f32_16x16x32_bf16 v[64:67], a[0:3], v[96:99], 0
    ds_read_b128 v[112:115], v2 offset:4096
    s_sub_u32 s52, s52, s18
    v_mfma_f32_16x16x32_bf16 v[68:71], a[4:7], v[96:99], 0
    s_add_u32 m0, s54, 28672
    s_add_u32 s5, s52, 28672
    buffer_load_dwordx4 v2, s[32:35], s5 offen offset:0 sc1 lds
    v_mfma_f32_16x16x32_bf16 v[72:75], a[8:11], v[96:99], 0
    buffer_load_dwordx4 v2, s[32:35], s5 offen offset:1024 sc1 lds
    v_mfma_f32_16x16x32_bf16 v[76:79], a[12:15], v[96:99], 0
    s_waitcnt lgkmcnt(3)
    v_mfma_f32_16x16x32_bf16 v[64:67], a[16:19], v[100:103], v[64:67]
    ds_read_b128 v[116:119], v2 offset:5120
    v_mfma_f32_16x16x32_bf16 v[68:71], a[20:23], v[100:103], v[68:71]
    buffer_load_dwordx4 v2, s[32:35], s5 offen offset:2048 sc1 lds
    v_mfma_f32_16x16x32_bf16 v[72:75], a[24:27], v[100:103], v[72:75]
    v_mfma_f32_16x16x32_bf16 v[76:79], a[28:31], v[100:103], v[76:79]
    s_waitcnt lgkmcnt(3)
    v_mfma_f32_16x16x32_bf16 v[64:67], a[32:35], v[104:107], v[64:67]
    ds_read_b128 v[96:99], v2 offset:6144
    buffer_load_dwordx4 v2, s[32:35], s5 offen offset:3072 sc1 lds
    v_mfma_f32_16x16x32_bf16 v[68:71], a[36:39], v[104:107], v[68:71]
    v_mfma_f32_16x16x32_bf16 v[72:75], a[40:43], v[104:107], v[72:75]
    v_mfma_f32_16x16x32_bf16 v[76:79], a[44:47], v[104:107], v[76:79]
    s_waitcnt lgkmcnt(3)
    s_add_u32 m0, s54, 32768
    s_add_u32 s5, s52, 32768
    v_mfma_f32_16x16x32_bf16 v[64:67], a[48:51], v[108:111], v[64:67]
    ds_read_b128 v[100:103], v2 offset:7168
    s_waitcnt vmcnt(7)
    v_mfma_f32_16x16x32_bf16 v[68:71], a[52:55], v[108:111], v[68:71]
    v_add_f32 v80, v80, v87
    v_add_f32 v81, v81, v88
    v_mfma_f32_16x16x32_bf16 v[72:75], a[56:59], v[108:111], v[72:75]
    v_add_f32 v82, v82, v89
    v_add_f32 v83, v83, v90
    v_mfma_f32_16x16x32_bf16 v[76:79], a[60:63], v[108:111], v[76:79]
    s_waitcnt lgkmcnt(3)
    v_add_f32 v84, v84, v91
    buffer_load_dwordx4 v2, s[32:35], s5 offen offset:0 sc1 lds
    v_mfma_f32_16x16x32_bf16 v[64:67], a[64:67], v[112:115], v[64:67]
    ds_read_b128 v[104:107], v2 offset:8192
    v_add_f32 v85, v85, v92
    v_mfma_f32_16x16x32_bf16 v[68:71], a[68:71], v[112:115], v[68:71]
    v_add_f32 v86, v86, v93
    buffer_load_dwordx4 v2, s[32:35], s5 offen offset:1024 sc1 lds
    v_mfma_f32_16x16x32_bf16 v[72:75], a[72:75], v[112:115], v[72:75]
    v_add_f32 v80, v80, v84
    buffer_load_dwordx4 v2, s[32:35], s5 offen offset:2048 sc1 lds
    v_mfma_f32_16x16x32_bf16 v[76:79], a[76:79], v[112:115], v[76:79]
    s_waitcnt lgkmcnt(3)
    v_add_f32 v81, v81, v85
    v_mfma_f32_16x16x32_bf16 v[64:67], a[80:83], v[116:119], v[64:67]
    ds_read_b128 v[108:111], v2 offset:9216
    v_add_f32 v82, v82, v86
    v_mfma_f32_16x16x32_bf16 v[68:71], a[84:87], v[116:119], v[68:71]
    v_add_f32 v80, v80, v82
    s_add_u32 m0, s51, 4096
    v_mfma_f32_16x16x32_bf16 v[72:75], a[88:91], v[116:119], v[72:75]
    v_add_f32 v81, v81, v83
    buffer_load_dwordx4 v12, s[24:27], s50 offen offset:0 lds
    v_mfma_f32_16x16x32_bf16 v[76:79], a[92:95], v[116:119], v[76:79]
    s_waitcnt lgkmcnt(3)
    v_add_f32 v80, v80, v81
    buffer_load_dwordx4 v13, s[24:27], s50 offen offset:1024 lds
    v_mfma_f32_16x16x32_bf16 v[64:67], a[96:99], v[96:99], v[64:67]
    ds_read_b128 v[112:115], v2 offset:10240
    v_mul_f32 v80, 0xbb124925, v80
    v_mfma_f32_16x16x32_bf16 v[68:71], a[100:103], v[96:99], v[68:71]
    v_mov_b32 v81, v80
    v_mfma_f32_16x16x32_bf16 v[72:75], a[104:107], v[96:99], v[72:75]
    s_nop 0
    v_permlane16_swap_b32 v80, v81
    buffer_load_dwordx4 v14, s[24:27], s50 offen offset:2048 lds
    v_mfma_f32_16x16x32_bf16 v[76:79], a[108:111], v[96:99], v[76:79]
    s_waitcnt lgkmcnt(3)
    v_fma_f32 v81, -v80, v80, -v81
    v_mfma_f32_16x16x32_bf16 v[64:67], a[112:115], v[100:103], v[64:67]
    ds_read_b128 v[116:119], v2 offset:11264
    v_max_f32 v81, 0, v81
    v_mfma_f32_16x16x32_bf16 v[68:71], a[116:119], v[100:103], v[68:71]
    v_add_f32 v81, 0x3727c5ac, v81
    buffer_load_dwordx4 v15, s[24:27], s50 offen offset:3072 lds
    v_mfma_f32_16x16x32_bf16 v[72:75], a[120:123], v[100:103], v[72:75]
    v_mov_b32 v84, v80
    v_mfma_f32_16x16x32_bf16 v[76:79], a[124:127], v[100:103], v[76:79]
    s_waitcnt lgkmcnt(3)
    v_rsq_f32 v80, v81
    v_mfma_f32_16x16x32_bf16 v[64:67], a[128:131], v[104:107], v[64:67]
    ds_read_b128 v[96:99], v2 offset:12288
    s_add_u32 s50, s50, 28672
    v_mfma_f32_16x16x32_bf16 v[68:71], a[132:135], v[104:107], v[68:71]
    v_mul_f32 v85, 0xbfb8aa3b, v80
    s_add_u32 m0, s51, 8192
    v_mfma_f32_16x16x32_bf16 v[72:75], a[136:139], v[104:107], v[72:75]
    v_mul_f32 v86, v80, v81
    buffer_load_dwordx4 v12, s[24:27], s50 offen offset:0 lds
    v_mfma_f32_16x16x32_bf16 v[76:79], a[140:143], v[104:107], v[76:79]
    s_waitcnt lgkmcnt(3)
    ds_write_b96 v7, v[84:86]
    buffer_load_dwordx4 v13, s[24:27], s50 offen offset:1024 lds
    v_mfma_f32_16x16x32_bf16 v[64:67], a[144:147], v[108:111], v[64:67]
    ds_read_b128 v[100:103], v2 offset:13312
    v_mfma_f32_16x16x32_bf16 v[68:71], a[148:151], v[108:111], v[68:71]
    buffer_load_dwordx4 v14, s[24:27], s50 offen offset:2048 lds
    v_mfma_f32_16x16x32_bf16 v[72:75], a[152:155], v[108:111], v[72:75]
    v_mfma_f32_16x16x32_bf16 v[76:79], a[156:159], v[108:111], v[76:79]
    s_waitcnt lgkmcnt(4)
    v_mfma_f32_16x16x32_bf16 v[64:67], a[160:163], v[112:115], v[64:67]
    buffer_load_dwordx4 v15, s[24:27], s50 offen offset:3072 lds
    v_mfma_f32_16x16x32_bf16 v[68:71], a[164:167], v[112:115], v[68:71]
    v_mfma_f32_16x16x32_bf16 v[72:75], a[168:171], v[112:115], v[72:75]
    v_mfma_f32_16x16x32_bf16 v[76:79], a[172:175], v[112:115], v[76:79]
    s_waitcnt lgkmcnt(3)
    s_add_u32 s50, s50, 28672
    s_add_u32 m0, s51, 49152
    v_mfma_f32_16x16x32_bf16 v[64:67], a[176:179], v[116:119], v[64:67]
    s_waitcnt vmcnt(15) lgkmcnt(1)
    s_barrier
    buffer_load_dwordx4 v12, s[24:27], s50 offen offset:0 lds
    v_mfma_f32_16x16x32_bf16 v[68:71], a[180:183], v[116:119], v[68:71]
    ds_read_b128 v[104:107], v2 offset:14336
    v_mfma_f32_16x16x32_bf16 v[72:75], a[184:187], v[116:119], v[72:75]
    ds_read_b128 v[108:111], v2 offset:15360
    buffer_load_dwordx4 v13, s[24:27], s50 offen offset:1024 lds
    v_mfma_f32_16x16x32_bf16 v[76:79], a[188:191], v[116:119], v[76:79]
    s_waitcnt lgkmcnt(4)
    v_mfma_f32_16x16x32_bf16 v[64:67], a[192:195], v[96:99], v[64:67]
    ds_read_b128 v[112:115], v2 offset:16384
    v_mfma_f32_16x16x32_bf16 v[68:71], a[196:199], v[96:99], v[68:71]
    buffer_load_dwordx4 v14, s[24:27], s50 offen offset:2048 lds
    v_mfma_f32_16x16x32_bf16 v[72:75], a[200:203], v[96:99], v[72:75]
    v_mfma_f32_16x16x32_bf16 v[76:79], a[204:207], v[96:99], v[76:79]
    s_waitcnt lgkmcnt(3)
    v_mfma_f32_16x16x32_bf16 v[64:67], a[208:211], v[100:103], v[64:67]
    ds_read_b128 v[116:119], v2 offset:17408
    buffer_load_dwordx4 v15, s[24:27], s50 offen offset:3072 lds
    v_mfma_f32_16x16x32_bf16 v[68:71], a[212:215], v[100:103], v[68:71]
    ds_read_b96 v[120:122], v20 offset:0
    v_mfma_f32_16x16x32_bf16 v[72:75], a[216:219], v[100:103], v[72:75]
    s_add_u32 s50, s50, 28672
    v_mfma_f32_16x16x32_bf16 v[76:79], a[220:223], v[100:103], v[76:79]
    s_waitcnt lgkmcnt(4)
    v_mfma_f32_16x16x32_bf16 v[80:83], a[0:3], v[104:107], 0
    ds_read_b128 v[96:99], v2 offset:18432
    s_waitcnt vmcnt(8)
    v_mfma_f32_16x16x32_bf16 v[84:87], a[4:7], v[104:107], 0
    ds_read_b64_tr_b16 v[192:193], v8 offset:4096
    v_mfma_f32_16x16x32_bf16 v[88:91], a[8:11], v[104:107], 0
    ds_read_b64_tr_b16 v[194:195], v8 offset:6144
    v_mfma_f32_16x16x32_bf16 v[92:95], a[12:15], v[104:107], 0
    s_waitcnt lgkmcnt(6)
    s_waitcnt lgkmcnt(3)
    v_fmac_f32 v64, v48, v120
    v_mfma_f32_16x16x32_bf16 v[80:83], a[16:19], v[108:111], v[80:83]
    ds_read_b128 v[100:103], v2 offset:19456
    v_fmac_f32 v65, v49, v120
    v_mfma_f32_16x16x32_bf16 v[84:87], a[20:23], v[108:111], v[84:87]
    v_fmac_f32 v66, v50, v120
    v_fmac_f32 v67, v51, v120
    v_mfma_f32_16x16x32_bf16 v[88:91], a[24:27], v[108:111], v[88:91]
    v_fmac_f32 v68, v52, v120
    v_fmac_f32 v69, v53, v120
    v_mfma_f32_16x16x32_bf16 v[92:95], a[28:31], v[108:111], v[92:95]
    s_waitcnt lgkmcnt(6)
    v_fmac_f32 v70, v54, v120
    v_fmac_f32 v71, v55, v120
    v_mfma_f32_16x16x32_bf16 v[80:83], a[32:35], v[112:115], v[80:83]
    ds_read_b128 v[104:107], v2 offset:20480
    v_mul_f32 v64, v64, v121
    v_mfma_f32_16x16x32_bf16 v[84:87], a[36:39], v[112:115], v[84:87]
    v_mul_f32 v65, v65, v121
    v_mul_f32 v66, v66, v121
    v_mfma_f32_16x16x32_bf16 v[88:91], a[40:43], v[112:115], v[88:91]
    v_mul_f32 v67, v67, v121
    ds_read_b64_tr_b16 v[196:197], v9 offset:4096
    v_mfma_f32_16x16x32_bf16 v[92:95], a[44:47], v[112:115], v[92:95]
    s_waitcnt lgkmcnt(7)
    v_mul_f32 v68, v68, v121
    v_mul_f32 v69, v69, v121
    v_mfma_f32_16x16x32_bf16 v[80:83], a[48:51], v[116:119], v[80:83]
    ds_read_b128 v[108:111], v2 offset:21504
    v_mul_f32 v70, v70, v121
    v_mfma_f32_16x16x32_bf16 v[84:87], a[52:55], v[116:119], v[84:87]
    v_mul_f32 v71, v71, v121
    ds_read_b64_tr_b16 v[198:199], v9 offset:6144
    v_mfma_f32_16x16x32_bf16 v[88:91], a[56:59], v[116:119], v[88:91]
    v_exp_f32 v64, v64
    v_mfma_f32_16x16x32_bf16 v[92:95], a[60:63], v[116:119], v[92:95]
    s_waitcnt lgkmcnt(7)
    v_exp_f32 v65, v65
    v_mfma_f32_16x16x32_bf16 v[80:83], a[64:67], v[96:99], v[80:83]
    ds_read_b128 v[112:115], v2 offset:22528
    ds_read_b64_tr_b16 v[200:201], v10 offset:4096
    v_mfma_f32_16x16x32_bf16 v[84:87], a[68:71], v[96:99], v[84:87]
    v_exp_f32 v66, v66
    v_mfma_f32_16x16x32_bf16 v[88:91], a[72:75], v[96:99], v[88:91]
    v_exp_f32 v67, v67
    v_mfma_f32_16x16x32_bf16 v[92:95], a[76:79], v[96:99], v[92:95]
    s_waitcnt lgkmcnt(6)
    v_exp_f32 v68, v68
    v_mfma_f32_16x16x32_bf16 v[80:83], a[80:83], v[100:103], v[80:83]
    ds_read_b128 v[116:119], v2 offset:23552
    ds_read_b64_tr_b16 v[202:203], v10 offset:6144
    v_mfma_f32_16x16x32_bf16 v[84:87], a[84:87], v[100:103], v[84:87]
    v_exp_f32 v69, v69
    v_mfma_f32_16x16x32_bf16 v[88:91], a[88:91], v[100:103], v[88:91]
    v_exp_f32 v70, v70
    v_mfma_f32_16x16x32_bf16 v[92:95], a[92:95], v[100:103], v[92:95]
    s_waitcnt lgkmcnt(7)
    v_exp_f32 v71, v71
    v_mfma_f32_16x16x32_bf16 v[80:83], a[96:99], v[104:107], v[80:83]
    ds_read_b128 v[96:99], v2 offset:24576
    ds_read_b64_tr_b16 v[204:205], v11 offset:4096
    v_mfma_f32_16x16x32_bf16 v[84:87], a[100:103], v[104:107], v[84:87]
    v_fmac_f32 v72, v56, v120
    v_fmac_f32 v73, v57, v120
    v_mfma_f32_16x16x32_bf16 v[88:91], a[104:107], v[104:107], v[88:91]
    v_fmac_f32 v74, v58, v120
    ds_read_b64_tr_b16 v[206:207], v11 offset:6144
    v_mfma_f32_16x16x32_bf16 v[92:95], a[108:111], v[104:107], v[92:95]
    s_waitcnt lgkmcnt(8)
    v_fmac_f32 v75, v59, v120
    v_fmac_f32 v76, v60, v120
    v_mfma_f32_16x16x32_bf16 v[80:83], a[112:115], v[108:111], v[80:83]
    ds_read_b128 v[100:103], v2 offset:25600
    v_fmac_f32 v77, v61, v120
    v_mfma_f32_16x16x32_bf16 v[84:87], a[116:119], v[108:111], v[84:87]
    v_fmac_f32 v78, v62, v120
    v_fmac_f32 v79, v63, v120
    v_mfma_f32_16x16x32_bf16 v[88:91], a[120:123], v[108:111], v[88:91]
    v_fma_f32 v64, v64, v122, v122
    s_waitcnt vmcnt(4)
    v_mfma_f32_16x16x32_bf16 v[92:95], a[124:127], v[108:111], v[92:95]
    s_waitcnt lgkmcnt(7)
    v_fma_f32 v65, v65, v122, v122
    v_fma_f32 v66, v66, v122, v122
    v_mfma_f32_16x16x32_bf16 v[80:83], a[128:131], v[112:115], v[80:83]
    ds_read_b128 v[104:107], v2 offset:26624
    v_fma_f32 v67, v67, v122, v122
    v_mfma_f32_16x16x32_bf16 v[84:87], a[132:135], v[112:115], v[84:87]
    v_fma_f32 v68, v68, v122, v122
    v_fma_f32 v69, v69, v122, v122
    v_mfma_f32_16x16x32_bf16 v[88:91], a[136:139], v[112:115], v[88:91]
    v_fma_f32 v70, v70, v122, v122
    ds_read_b64_tr_b16 v[208:209], v8 offset:8192
    v_mfma_f32_16x16x32_bf16 v[92:95], a[140:143], v[112:115], v[92:95]
    s_waitcnt lgkmcnt(7)
    v_fma_f32 v71, v71, v122, v122
    ds_read_b64_tr_b16 v[210:211], v8 offset:10240
    v_mfma_f32_16x16x32_bf16 v[80:83], a[144:147], v[116:119], v[80:83]
    ds_read_b128 v[108:111], v2 offset:27648
    ds_read_b64_tr_b16 v[212:213], v9 offset:8192
    v_mfma_f32_16x16x32_bf16 v[84:87], a[148:151], v[116:119], v[84:87]
    v_rcp_f32 v64, v64
    v_mfma_f32_16x16x32_bf16 v[88:91], a[152:155], v[116:119], v[88:91]
    v_rcp_f32 v65, v65
    v_mfma_f32_16x16x32_bf16 v[92:95], a[156:159], v[116:119], v[92:95]
    s_waitcnt lgkmcnt(8)
    v_rcp_f32 v66, v66
    v_mfma_f32_16x16x32_bf16 v[80:83], a[160:163], v[96:99], v[80:83]
    v_rcp_f32 v67, v67
    v_mfma_f32_16x16x32_bf16 v[84:87], a[164:167], v[96:99], v[84:87]
    v_rcp_f32 v68, v68
    v_mfma_f32_16x16x32_bf16 v[88:91], a[168:171], v[96:99], v[88:91]
    v_rcp_f32 v69, v69
    v_mfma_f32_16x16x32_bf16 v[92:95], a[172:175], v[96:99], v[92:95]
    s_waitcnt lgkmcnt(5)
    ds_read_b64_tr_b16 v[214:215], v9 offset:10240
    ds_read_b64_tr_b16 v[216:217], v10 offset:8192
    v_mfma_f32_16x16x32_bf16 v[80:83], a[176:179], v[100:103], v[80:83]
    s_waitcnt vmcnt(12) lgkmcnt(3)
    s_barrier
    ds_read_b64_tr_b16 v[218:219], v10 offset:10240
    ds_read_b64_tr_b16 v[220:221], v11 offset:8192
    ds_read_b64_tr_b16 v[222:223], v11 offset:10240
    s_add_u32 m0, s51, 53248
    s_nop 0
    buffer_load_dwordx4 v12, s[24:27], s50 offen offset:0 lds
    buffer_load_dwordx4 v13, s[24:27], s50 offen offset:1024 lds
    buffer_load_dwordx4 v14, s[24:27], s50 offen offset:2048 lds
    buffer_load_dwordx4 v15, s[24:27], s50 offen offset:3072 lds
    s_add_u32 s50, s50, 28672
    v_mfma_f32_16x16x32_bf16 v[84:87], a[180:183], v[100:103], v[84:87]
    ds_read_b128 v[112:115], v2 offset:28672
    v_mfma_f32_16x16x32_bf16 v[88:91], a[184:187], v[100:103], v[88:91]
    ds_read_b128 v[116:119], v2 offset:29696
    v_mfma_f32_16x16x32_bf16 v[92:95], a[188:191], v[100:103], v[92:95]
    s_waitcnt lgkmcnt(11)
    v_rcp_f32 v70, v70
    v_mfma_f32_16x16x32_bf16 v[80:83], a[192:195], v[104:107], v[80:83]
    ds_read_b128 v[96:99], v2 offset:30720
    s_add_u32 s52, s52, s18
    v_mfma_f32_16x16x32_bf16 v[84:87], a[196:199], v[104:107], v[84:87]
    v_rcp_f32 v71, v71
    v_mfma_f32_16x16x32_bf16 v[88:91], a[200:203], v[104:107], v[88:91]
    v_mul_f32 v64, v64, v72
    v_mul_f32 v65, v65, v73
    v_mfma_f32_16x16x32_bf16 v[92:95], a[204:207], v[104:107], v[92:95]
    s_waitcnt lgkmcnt(9)
    v_mul_f32 v66, v66, v74
    v_mul_f32 v67, v67, v75
    v_mfma_f32_16x16x32_bf16 v[80:83], a[208:211], v[108:111], v[80:83]
    ds_read_b128 v[100:103], v2 offset:31744
    v_mul_f32 v68, v68, v76
    v_mfma_f32_16x16x32_bf16 v[84:87], a[212:215], v[108:111], v[84:87]
    ds_read_b96 v[124:126], v20 offset:256
    v_mul_f32 v69, v69, v77
    v_mfma_f32_16x16x32_bf16 v[88:91], a[216:219], v[108:111], v[88:91]
    v_mul_f32 v70, v70, v78
    v_mul_f32 v71, v71, v79
    v_mfma_f32_16x16x32_bf16 v[92:95], a[220:223], v[108:111], v[92:95]
    s_waitcnt lgkmcnt(4)
    v_cvt_pk_bf16_f32 v16, v64, v65
    v_cvt_pk_bf16_f32 v17, v66, v67
    v_cvt_pk_bf16_f32 v18, v68, v69
    v_cvt_pk_bf16_f32 v19, v70, v71
    buffer_store_dwordx4 v[16:19], v2, s[32:35], s53 offen sc1
    s_add_u32 s53, s53, 57344
    v_mfma_f32_16x16x32_bf16 v[64:67], a[0:3], v[112:115], 0
    ds_read_b128 v[104:107], v2 offset:32768
    s_add_u32 m0, s54, 0
    v_mfma_f32_16x16x32_bf16 v[68:71], a[4:7], v[112:115], 0
    s_add_u32 s5, s52, 57344
    buffer_load_dwordx4 v2, s[32:35], s5 offen offset:0 sc1 lds
    buffer_load_dwordx4 v2, s[32:35], s5 offen offset:1024 sc1 lds
    v_mfma_f32_16x16x32_bf16 v[72:75], a[8:11], v[112:115], 0
    buffer_load_dwordx4 v2, s[32:35], s5 offen offset:2048 sc1 lds
    buffer_load_dwordx4 v2, s[32:35], s5 offen offset:3072 sc1 lds
    v_mfma_f32_16x16x32_bf16 v[76:79], a[12:15], v[112:115], 0
    s_waitcnt lgkmcnt(4)
    s_waitcnt lgkmcnt(1)
    v_fmac_f32 v80, v48, v124
    v_mfma_f32_16x16x32_bf16 v[64:67], a[16:19], v[116:119], v[64:67]
    ds_read_b128 v[108:111], v2 offset:33792
    v_fmac_f32 v81, v49, v124
    v_mfma_f32_16x16x32_bf16 v[68:71], a[20:23], v[116:119], v[68:71]
    v_fmac_f32 v82, v50, v124
    v_fmac_f32 v83, v51, v124
    v_mfma_f32_16x16x32_bf16 v[72:75], a[24:27], v[116:119], v[72:75]
    v_fmac_f32 v84, v52, v124
    v_fmac_f32 v85, v53, v124
    v_mfma_f32_16x16x32_bf16 v[76:79], a[28:31], v[116:119], v[76:79]
    s_waitcnt lgkmcnt(4)
    v_fmac_f32 v86, v54, v124
    v_fmac_f32 v87, v55, v124
    v_mfma_f32_16x16x32_bf16 v[64:67], a[32:35], v[96:99], v[64:67]
    ds_read_b128 v[112:115], v2 offset:34816
    v_mul_f32 v80, v80, v125
    v_mfma_f32_16x16x32_bf16 v[68:71], a[36:39], v[96:99], v[68:71]
    v_mul_f32 v81, v81, v125
    v_mul_f32 v82, v82, v125
    v_mfma_f32_16x16x32_bf16 v[72:75], a[40:43], v[96:99], v[72:75]
    v_mul_f32 v83, v83, v125
    s_add_u32 m0, s54, 4096
    v_mfma_f32_16x16x32_bf16 v[76:79], a[44:47], v[96:99], v[76:79]
    s_waitcnt lgkmcnt(4)
    v_mul_f32 v84, v84, v125
    v_mul_f32 v85, v85, v125
    v_mfma_f32_16x16x32_bf16 v[64:67], a[48:51], v[100:103], v[64:67]
    ds_read_b128 v[116:119], v2 offset:35840
    v_mul_f32 v86, v86, v125
    v_mfma_f32_16x16x32_bf16 v[68:71], a[52:55], v[100:103], v[68:71]
    v_mul_f32 v87, v87, v125
    s_add_u32 s5, s52, 61440
    v_mfma_f32_16x16x32_bf16 v[72:75], a[56:59], v[100:103], v[72:75]
    v_exp_f32 v80, v80
    v_mfma_f32_16x16x32_bf16 v[76:79], a[60:63], v[100:103], v[76:79]
    s_waitcnt lgkmcnt(3)
    v_exp_f32 v81, v81
    v_mfma_f32_16x16x32_bf16 v[64:67], a[64:67], v[104:107], v[64:67]
    ds_read_b128 v[96:99], v2 offset:36864
    buffer_load_dwordx4 v2, s[32:35], s5 offen offset:0 sc1 lds
    v_mfma_f32_16x16x32_bf16 v[68:71], a[68:71], v[104:107], v[68:71]
    v_exp_f32 v82, v82
    v_mfma_f32_16x16x32_bf16 v[72:75], a[72:75], v[104:107], v[72:75]
    v_exp_f32 v83, v83
    buffer_load_dwordx4 v2, s[32:35], s5 offen offset:1024 sc1 lds
    buffer_load_dwordx4 v2, s[32:35], s5 offen offset:2048 sc1 lds
    v_mfma_f32_16x16x32_bf16 v[76:79], a[76:79], v[104:107], v[76:79]
    s_waitcnt lgkmcnt(3)
    v_exp_f32 v84, v84
    v_mfma_f32_16x16x32_bf16 v[64:67], a[80:83], v[108:111], v[64:67]
    ds_read_b128 v[100:103], v2 offset:37888
    s_add_u32 m0, s51, 57344
    v_mfma_f32_16x16x32_bf16 v[68:71], a[84:87], v[108:111], v[68:71]
    v_exp_f32 v85, v85
    v_mfma_f32_16x16x32_bf16 v[72:75], a[88:91], v[108:111], v[72:75]
    v_exp_f32 v86, v86
    v_mfma_f32_16x16x32_bf16 v[76:79], a[92:95], v[108:111], v[76:79]
    s_waitcnt lgkmcnt(3)
    v_exp_f32 v87, v87
    v_mfma_f32_16x16x32_bf16 v[64:67], a[96:99], v[112:115], v[64:67]
    ds_read_b128 v[104:107], v2 offset:38912
    buffer_load_dwordx4 v12, s[24:27], s50 offen offset:0 lds
    v_mfma_f32_16x16x32_bf16 v[68:71], a[100:103], v[112:115], v[68:71]
    v_fmac_f32 v88, v56, v124
    v_fmac_f32 v89, v57, v124
    v_mfma_f32_16x16x32_bf16 v[72:75], a[104:107], v[112:115], v[72:75]
    v_fmac_f32 v90, v58, v124
    buffer_load_dwordx4 v13, s[24:27], s50 offen offset:1024 lds
    v_mfma_f32_16x16x32_bf16 v[76:79], a[108:111], v[112:115], v[76:79]
    s_waitcnt lgkmcnt(3)
    v_fmac_f32 v91, v59, v124
    v_fmac_f32 v92, v60, v124
    v_mfma_f32_16x16x32_bf16 v[64:67], a[112:115], v[116:119], v[64:67]
    ds_read_b128 v[108:111], v2 offset:39936
    v_fmac_f32 v93, v61, v124
    v_mfma_f32_16x16x32_bf16 v[68:71], a[116:119], v[116:119], v[68:71]
    v_fmac_f32 v94, v62, v124
    v_fmac_f32 v95, v63, v124
    v_mfma_f32_16x16x32_bf16 v[72:75], a[120:123], v[116:119], v[72:75]
    v_fma_f32 v80, v80, v126, v126
    buffer_load_dwordx4 v14, s[24:27], s50 offen offset:2048 lds
    v_mfma_f32_16x16x32_bf16 v[76:79], a[124:127], v[116:119], v[76:79]
    s_waitcnt lgkmcnt(3)
    v_fma_f32 v81, v81, v126, v126
    v_fma_f32 v82, v82, v126, v126
    v_mfma_f32_16x16x32_bf16 v[64:67], a[128:131], v[96:99], v[64:67]
    ds_read_b128 v[112:115], v2 offset:40960
    v_fma_f32 v83, v83, v126, v126
    v_mfma_f32_16x16x32_bf16 v[68:71], a[132:135], v[96:99], v[68:71]
    v_fma_f32 v84, v84, v126, v126
    v_fma_f32 v85, v85, v126, v126
    v_mfma_f32_16x16x32_bf16 v[72:75], a[136:139], v[96:99], v[72:75]
sequential_preLN__softmax_full_mha__glu_gated_glu__prompt_kernel_pg6:
    s_cbranch_execz sequential_preLN__softmax_full_mha__glu_gated_glu__prompt_kernel_tb5
    v_fma_f32 v86, v86, v126, v126
    buffer_load_dwordx4 v15, s[24:27], s50 offen offset:3072 lds
    v_mfma_f32_16x16x32_bf16 v[76:79], a[140:143], v[96:99], v[76:79]
    s_waitcnt lgkmcnt(3)
    v_fma_f32 v87, v87, v126, v126
    v_mfma_f32_16x16x32_bf16 v[64:67], a[144:147], v[100:103], v[64:67]
    ds_read_b128 v[116:119], v2 offset:41984
    v_mfma_f32_16x16x32_bf16 v[68:71], a[148:151], v[100:103], v[68:71]
    v_rcp_f32 v80, v80
    v_mfma_f32_16x16x32_bf16 v[72:75], a[152:155], v[100:103], v[72:75]
    v_rcp_f32 v81, v81
    v_mfma_f32_16x16x32_bf16 v[76:79], a[156:159], v[100:103], v[76:79]
    s_waitcnt lgkmcnt(3)
    v_rcp_f32 v82, v82
    v_mfma_f32_16x16x32_bf16 v[64:67], a[160:163], v[104:107], v[64:67]
    ds_read_b128 v[96:99], v2 offset:43008
    s_add_u32 s50, s50, 28672
    v_mfma_f32_16x16x32_bf16 v[68:71], a[164:167], v[104:107], v[68:71]
    v_rcp_f32 v83, v83
    v_mfma_f32_16x16x32_bf16 v[72:75], a[168:171], v[104:107], v[72:75]
    v_rcp_f32 v84, v84
    v_mfma_f32_16x16x32_bf16 v[76:79], a[172:175], v[104:107], v[76:79]
    s_waitcnt lgkmcnt(3)
    v_rcp_f32 v85, v85
    v_mfma_f32_16x16x32_bf16 v[64:67], a[176:179], v[108:111], v[64:67]
    ds_read_b128 v[100:103], v2 offset:44032
    s_waitcnt vmcnt(16)
    v_mfma_f32_16x16x32_bf16 v[68:71], a[180:183], v[108:111], v[68:71]
    v_rcp_f32 v86, v86
    v_mfma_f32_16x16x32_bf16 v[72:75], a[184:187], v[108:111], v[72:75]
    v_rcp_f32 v87, v87
    v_mfma_f32_16x16x32_bf16 v[76:79], a[188:191], v[108:111], v[76:79]
    s_waitcnt lgkmcnt(3)
    v_mul_f32 v80, v80, v88
    v_mul_f32 v81, v81, v89
    v_mfma_f32_16x16x32_bf16 v[64:67], a[192:195], v[112:115], v[64:67]
    ds_read_b128 v[104:107], v2 offset:45056
    v_mul_f32 v82, v82, v90
    v_mfma_f32_16x16x32_bf16 v[68:71], a[196:199], v[112:115], v[68:71]
    v_mul_f32 v83, v83, v91
    v_mul_f32 v84, v84, v92
    v_mfma_f32_16x16x32_bf16 v[72:75], a[200:203], v[112:115], v[72:75]
    v_mul_f32 v85, v85, v93
    ds_read_b64_tr_b16 v[224:225], v8 offset:49152
    v_mfma_f32_16x16x32_bf16 v[76:79], a[204:207], v[112:115], v[76:79]
    s_waitcnt lgkmcnt(4)
    v_mul_f32 v86, v86, v94
    v_mul_f32 v87, v87, v95
    v_mfma_f32_16x16x32_bf16 v[64:67], a[208:211], v[116:119], v[64:67]
    ds_read_b128 v[108:111], v2 offset:46080
    v_cvt_pk_bf16_f32 v16, v80, v81
    v_mfma_f32_16x16x32_bf16 v[68:71], a[212:215], v[116:119], v[68:71]
    ds_read_b96 v[120:122], v20 offset:512
    v_cvt_pk_bf16_f32 v17, v82, v83
    v_mfma_f32_16x16x32_bf16 v[72:75], a[216:219], v[116:119], v[72:75]
    v_cvt_pk_bf16_f32 v18, v84, v85
    v_cvt_pk_bf16_f32 v19, v86, v87
    v_mfma_f32_16x16x32_bf16 v[76:79], a[220:223], v[116:119], v[76:79]
    s_waitcnt lgkmcnt(5)
    buffer_store_dwordx4 v[16:19], v2, s[32:35], s53 offen sc1
    s_add_u32 s53, s53, 57344
    v_mfma_f32_16x16x32_bf16 v[80:83], a[0:3], v[96:99], 0
    ds_read_b128 v[112:115], v2 offset:47104
    ds_read_b64_tr_b16 v[226:227], v8 offset:51200
    v_mfma_f32_16x16x32_bf16 v[84:87], a[4:7], v[96:99], 0
    ds_read_b64_tr_b16 v[228:229], v9 offset:49152
    ds_read_b64_tr_b16 v[230:231], v9 offset:51200
    v_mfma_f32_16x16x32_bf16 v[88:91], a[8:11], v[96:99], 0
    ds_read_b64_tr_b16 v[232:233], v10 offset:49152
    v_mfma_f32_16x16x32_bf16 v[92:95], a[12:15], v[96:99], 0
    s_waitcnt lgkmcnt(9)
    s_waitcnt lgkmcnt(5)
    v_fmac_f32 v64, v48, v120
    v_mfma_f32_16x16x32_bf16 v[80:83], a[16:19], v[100:103], v[80:83]
    ds_read_b128 v[116:119], v2 offset:48128
    v_fmac_f32 v65, v49, v120
    v_mfma_f32_16x16x32_bf16 v[84:87], a[20:23], v[100:103], v[84:87]
    v_fmac_f32 v66, v50, v120
    v_fmac_f32 v67, v51, v120
    v_mfma_f32_16x16x32_bf16 v[88:91], a[24:27], v[100:103], v[88:91]
    v_fmac_f32 v68, v52, v120
    v_fmac_f32 v69, v53, v120
    v_mfma_f32_16x16x32_bf16 v[92:95], a[28:31], v[100:103], v[92:95]
    s_waitcnt lgkmcnt(9)
    v_fmac_f32 v70, v54, v120
    v_fmac_f32 v71, v55, v120
    v_mfma_f32_16x16x32_bf16 v[80:83], a[32:35], v[104:107], v[80:83]
    ds_read_b128 v[96:99], v2 offset:49152
    v_mul_f32 v64, v64, v121
    v_mfma_f32_16x16x32_bf16 v[84:87], a[36:39], v[104:107], v[84:87]
    v_mul_f32 v65, v65, v121
    v_mul_f32 v66, v66, v121
    v_mfma_f32_16x16x32_bf16 v[88:91], a[40:43], v[104:107], v[88:91]
    v_mul_f32 v67, v67, v121
    ds_read_b64_tr_b16 v[234:235], v10 offset:51200
    v_mfma_f32_16x16x32_bf16 v[92:95], a[44:47], v[104:107], v[92:95]
    s_waitcnt lgkmcnt(9)
    v_mul_f32 v68, v68, v121
    v_mul_f32 v69, v69, v121
    v_mfma_f32_16x16x32_bf16 v[80:83], a[48:51], v[108:111], v[80:83]
    ds_read_b128 v[100:103], v2 offset:50176
    v_mul_f32 v70, v70, v121
    v_mfma_f32_16x16x32_bf16 v[84:87], a[52:55], v[108:111], v[84:87]
    v_mul_f32 v71, v71, v121
    ds_read_b64_tr_b16 v[236:237], v11 offset:49152
    v_mfma_f32_16x16x32_bf16 v[88:91], a[56:59], v[108:111], v[88:91]
    v_exp_f32 v64, v64
    v_mfma_f32_16x16x32_bf16 v[92:95], a[60:63], v[108:111], v[92:95]
    s_waitcnt lgkmcnt(9)
    v_exp_f32 v65, v65
    v_mfma_f32_16x16x32_bf16 v[80:83], a[64:67], v[112:115], v[80:83]
    ds_read_b128 v[104:107], v2 offset:51200
    v_mfma_f32_16x16x32_bf16 v[84:87], a[68:71], v[112:115], v[84:87]
    v_exp_f32 v66, v66
    v_mfma_f32_16x16x32_bf16 v[88:91], a[72:75], v[112:115], v[88:91]
    v_exp_f32 v67, v67
    v_mfma_f32_16x16x32_bf16 v[92:95], a[76:79], v[112:115], v[92:95]
    s_waitcnt lgkmcnt(5)
    v_exp_f32 v68, v68
    v_mfma_f32_16x16x32_bf16 v[80:83], a[80:83], v[116:119], v[80:83]
    ds_read_b128 v[108:111], v2 offset:52224
    ds_read_b64_tr_b16 v[238:239], v11 offset:51200
    v_mfma_f32_16x16x32_bf16 v[84:87], a[84:87], v[116:119], v[84:87]
    v_exp_f32 v69, v69
    v_mfma_f32_16x16x32_bf16 v[88:91], a[88:91], v[116:119], v[88:91]
    v_exp_f32 v70, v70
    v_mfma_f32_16x16x32_bf16 v[92:95], a[92:95], v[116:119], v[92:95]
    s_waitcnt lgkmcnt(6)
    v_exp_f32 v71, v71
    v_mfma_f32_16x16x32_bf16 v[80:83], a[96:99], v[96:99], v[80:83]
    ds_read_b128 v[112:115], v2 offset:53248
    s_add_u32 m0, s51, 0
    v_mfma_f32_16x16x32_bf16 v[84:87], a[100:103], v[96:99], v[84:87]
    v_fmac_f32 v72, v56, v120
    v_fmac_f32 v73, v57, v120
    v_mfma_f32_16x16x32_bf16 v[88:91], a[104:107], v[96:99], v[88:91]
    v_fmac_f32 v74, v58, v120
    buffer_load_dwordx4 v12, s[24:27], s50 offen offset:0 lds
    v_mfma_f32_16x16x32_bf16 v[92:95], a[108:111], v[96:99], v[92:95]
    s_waitcnt lgkmcnt(5)
    v_fmac_f32 v75, v59, v120
    v_fmac_f32 v76, v60, v120
    v_mfma_f32_16x16x32_bf16 v[80:83], a[112:115], v[100:103], v[80:83]
    ds_read_b128 v[116:119], v2 offset:54272
    v_fmac_f32 v77, v61, v120
    v_mfma_f32_16x16x32_bf16 v[84:87], a[116:119], v[100:103], v[84:87]
    v_fmac_f32 v78, v62, v120
    v_fmac_f32 v79, v63, v120
    v_mfma_f32_16x16x32_bf16 v[88:91], a[120:123], v[100:103], v[88:91]
    v_fma_f32 v64, v64, v122, v122
    buffer_load_dwordx4 v13, s[24:27], s50 offen offset:1024 lds
    v_mfma_f32_16x16x32_bf16 v[92:95], a[124:127], v[100:103], v[92:95]
    s_waitcnt lgkmcnt(4)
    v_fma_f32 v65, v65, v122, v122
    v_fma_f32 v66, v66, v122, v122
    v_mfma_f32_16x16x32_bf16 v[80:83], a[128:131], v[104:107], v[80:83]
    ds_read_b128 v[96:99], v2 offset:55296
    v_fma_f32 v67, v67, v122, v122
    v_mfma_f32_16x16x32_bf16 v[84:87], a[132:135], v[104:107], v[84:87]
    v_fma_f32 v68, v68, v122, v122
    v_fma_f32 v69, v69, v122, v122
    v_mfma_f32_16x16x32_bf16 v[88:91], a[136:139], v[104:107], v[88:91]
    v_fma_f32 v70, v70, v122, v122
    buffer_load_dwordx4 v14, s[24:27], s50 offen offset:2048 lds
    v_mfma_f32_16x16x32_bf16 v[92:95], a[140:143], v[104:107], v[92:95]
    s_waitcnt lgkmcnt(4)
    v_fma_f32 v71, v71, v122, v122
    v_mfma_f32_16x16x32_bf16 v[80:83], a[144:147], v[108:111], v[80:83]
    ds_read_b128 v[100:103], v2 offset:56320
    v_mfma_f32_16x16x32_bf16 v[84:87], a[148:151], v[108:111], v[84:87]
    v_rcp_f32 v64, v64
    v_mfma_f32_16x16x32_bf16 v[88:91], a[152:155], v[108:111], v[88:91]
    v_rcp_f32 v65, v65
    v_mfma_f32_16x16x32_bf16 v[92:95], a[156:159], v[108:111], v[92:95]
    s_waitcnt lgkmcnt(3)
    v_rcp_f32 v66, v66
    v_mfma_f32_16x16x32_bf16 v[80:83], a[160:163], v[112:115], v[80:83]
    v_rcp_f32 v67, v67
    v_mfma_f32_16x16x32_bf16 v[84:87], a[164:167], v[112:115], v[84:87]
    s_waitcnt vmcnt(3)
    s_cmp_eq_u32 s38, 0
    s_cbranch_scc1 sequential_preLN__softmax_full_mha__glu_gated_glu__prompt_kernel_sb14a
    buffer_store_dword v30, v31, s[36:39], s58 offen offset:1280
sequential_preLN__softmax_full_mha__glu_gated_glu__prompt_kernel_sb14b:
    v_mfma_f32_16x16x32_bf16 v[88:91], a[168:171], v[112:115], v[88:91]
    v_rcp_f32 v68, v68
    buffer_load_dwordx4 v15, s[24:27], s50 offen offset:3072 lds
    s_add_u32 s50, s50, 28672
    v_mfma_f32_16x16x32_bf16 v[92:95], a[172:175], v[112:115], v[92:95]
    s_waitcnt lgkmcnt(2)
    v_rcp_f32 v69, v69
    v_mfma_f32_16x16x32_bf16 v[80:83], a[176:179], v[116:119], v[80:83]
    s_waitcnt vmcnt(10) lgkmcnt(0)
    s_barrier
    v_mfma_f32_16x16x32_bf16 v[84:87], a[180:183], v[116:119], v[84:87]
    ds_read_b128 v[104:107], v2 offset:0
    v_mfma_f32_16x16x32_bf16 v[88:91], a[184:187], v[116:119], v[88:91]
    ds_read_b128 v[108:111], v2 offset:1024
    v_mfma_f32_16x16x32_bf16 v[92:95], a[188:191], v[116:119], v[92:95]
    s_waitcnt lgkmcnt(3)
    v_rcp_f32 v70, v70
    v_mfma_f32_16x16x32_bf16 v[80:83], a[192:195], v[96:99], v[80:83]
    ds_read_b128 v[112:115], v2 offset:2048
    s_sub_u32 s52, s52, s18
    v_mfma_f32_16x16x32_bf16 v[84:87], a[196:199], v[96:99], v[84:87]
    v_rcp_f32 v71, v71
    v_mfma_f32_16x16x32_bf16 v[88:91], a[200:203], v[96:99], v[88:91]
    v_mul_f32 v64, v64, v72
    v_mul_f32 v65, v65, v73
    v_mfma_f32_16x16x32_bf16 v[92:95], a[204:207], v[96:99], v[92:95]
    s_waitcnt lgkmcnt(3)
    v_mul_f32 v66, v66, v74
    v_mul_f32 v67, v67, v75
    v_mfma_f32_16x16x32_bf16 v[80:83], a[208:211], v[100:103], v[80:83]
    ds_read_b128 v[116:119], v2 offset:3072
    v_mul_f32 v68, v68, v76
    v_mfma_f32_16x16x32_bf16 v[84:87], a[212:215], v[100:103], v[84:87]
    ds_read_b96 v[124:126], v20 offset:768
    v_mul_f32 v69, v69, v77
    v_mfma_f32_16x16x32_bf16 v[88:91], a[216:219], v[100:103], v[88:91]
    v_mul_f32 v70, v70, v78
    v_mul_f32 v71, v71, v79
    v_mfma_f32_16x16x32_bf16 v[92:95], a[220:223], v[100:103], v[92:95]
    s_waitcnt lgkmcnt(4)
    v_cvt_pk_bf16_f32 v16, v64, v65
    v_cvt_pk_bf16_f32 v17, v66, v67
    v_cvt_pk_bf16_f32 v18, v68, v69
    v_cvt_pk_bf16_f32 v19, v70, v71
    buffer_store_dwordx4 v[16:19], v2, s[32:35], s53 offen sc1
    s_add_u32 s53, s53, 57344
    v_mfma_f32_16x16x32_bf16 v[64:67], a[0:3], v[104:107], 0
    ds_read_b128 v[96:99], v2 offset:4096
    s_add_u32 m0, s54, 28672
    v_mfma_f32_16x16x32_bf16 v[68:71], a[4:7], v[104:107], 0
    s_add_u32 s5, s52, 86016
    buffer_load_dwordx4 v2, s[32:35], s5 offen offset:0 sc1 lds
    buffer_load_dwordx4 v2, s[32:35], s5 offen offset:1024 sc1 lds
    v_mfma_f32_16x16x32_bf16 v[72:75], a[8:11], v[104:107], 0
    buffer_load_dwordx4 v2, s[32:35], s5 offen offset:2048 sc1 lds
    buffer_load_dwordx4 v2, s[32:35], s5 offen offset:3072 sc1 lds
    v_mfma_f32_16x16x32_bf16 v[76:79], a[12:15], v[104:107], 0
    s_waitcnt lgkmcnt(4)
    s_waitcnt lgkmcnt(1)
    v_fmac_f32 v80, v48, v124
    v_mfma_f32_16x16x32_bf16 v[64:67], a[16:19], v[108:111], v[64:67]
    ds_read_b128 v[100:103], v2 offset:5120
    v_fmac_f32 v81, v49, v124
    v_mfma_f32_16x16x32_bf16 v[68:71], a[20:23], v[108:111], v[68:71]
    v_fmac_f32 v82, v50, v124
    v_fmac_f32 v83, v51, v124
    v_mfma_f32_16x16x32_bf16 v[72:75], a[24:27], v[108:111], v[72:75]
    v_fmac_f32 v84, v52, v124
    v_fmac_f32 v85, v53, v124
    v_mfma_f32_16x16x32_bf16 v[76:79], a[28:31], v[108:111], v[76:79]
    s_waitcnt lgkmcnt(4)
    v_fmac_f32 v86, v54, v124
    v_fmac_f32 v87, v55, v124
    v_mfma_f32_16x16x32_bf16 v[64:67], a[32:35], v[112:115], v[64:67]
    ds_read_b128 v[104:107], v2 offset:6144
    v_mul_f32 v80, v80, v125
    v_mfma_f32_16x16x32_bf16 v[68:71], a[36:39], v[112:115], v[68:71]
    v_mul_f32 v81, v81, v125
    v_mul_f32 v82, v82, v125
    v_mfma_f32_16x16x32_bf16 v[72:75], a[40:43], v[112:115], v[72:75]
    v_mul_f32 v83, v83, v125
    s_add_u32 m0, s54, 32768
    v_mfma_f32_16x16x32_bf16 v[76:79], a[44:47], v[112:115], v[76:79]
    s_waitcnt lgkmcnt(4)
    v_mul_f32 v84, v84, v125
    v_mul_f32 v85, v85, v125
    v_mfma_f32_16x16x32_bf16 v[64:67], a[48:51], v[116:119], v[64:67]
    ds_read_b128 v[108:111], v2 offset:7168
    v_mul_f32 v86, v86, v125
    v_mfma_f32_16x16x32_bf16 v[68:71], a[52:55], v[116:119], v[68:71]
    v_mul_f32 v87, v87, v125
    s_add_u32 s5, s52, 90112
    v_mfma_f32_16x16x32_bf16 v[72:75], a[56:59], v[116:119], v[72:75]
    v_exp_f32 v80, v80
    v_mfma_f32_16x16x32_bf16 v[76:79], a[60:63], v[116:119], v[76:79]
    s_waitcnt lgkmcnt(3)
    v_exp_f32 v81, v81
    v_mfma_f32_16x16x32_bf16 v[64:67], a[64:67], v[96:99], v[64:67]
    ds_read_b128 v[112:115], v2 offset:8192
    buffer_load_dwordx4 v2, s[32:35], s5 offen offset:0 sc1 lds
    buffer_load_dwordx4 v2, s[32:35], s5 offen offset:1024 sc1 lds
    buffer_load_dwordx4 v2, s[32:35], s5 offen offset:2048 sc1 lds
    v_mfma_f32_16x16x32_bf16 v[68:71], a[68:71], v[96:99], v[68:71]
    v_exp_f32 v82, v82
    v_mfma_f32_16x16x32_bf16 v[72:75], a[72:75], v[96:99], v[72:75]
    v_exp_f32 v83, v83
    v_mfma_f32_16x16x32_bf16 v[76:79], a[76:79], v[96:99], v[76:79]
    s_waitcnt lgkmcnt(3)
    v_exp_f32 v84, v84
    v_mfma_f32_16x16x32_bf16 v[64:67], a[80:83], v[100:103], v[64:67]
    ds_read_b128 v[116:119], v2 offset:9216
    s_waitcnt vmcnt(26)
    v_mfma_f32_16x16x32_bf16 v[68:71], a[84:87], v[100:103], v[68:71]
    v_exp_f32 v85, v85
    v_mfma_f32_16x16x32_bf16 v[72:75], a[88:91], v[100:103], v[72:75]
    v_exp_f32 v86, v86
    v_mfma_f32_16x16x32_bf16 v[76:79], a[92:95], v[100:103], v[76:79]
    s_waitcnt lgkmcnt(3)
    v_exp_f32 v87, v87
    v_mfma_f32_16x16x32_bf16 v[64:67], a[96:99], v[104:107], v[64:67]
    ds_read_b128 v[96:99], v2 offset:10240
    ds_read_b64_tr_b16 v[240:241], v8 offset:53248
    v_mfma_f32_16x16x32_bf16 v[68:71], a[100:103], v[104:107], v[68:71]
    v_fmac_f32 v88, v56, v124
    v_fmac_f32 v89, v57, v124
    v_mfma_f32_16x16x32_bf16 v[72:75], a[104:107], v[104:107], v[72:75]
    v_fmac_f32 v90, v58, v124
    ds_read_b64_tr_b16 v[242:243], v8 offset:55296
    v_mfma_f32_16x16x32_bf16 v[76:79], a[108:111], v[104:107], v[76:79]
    s_waitcnt lgkmcnt(5)
    v_fmac_f32 v91, v59, v124
    v_fmac_f32 v92, v60, v124
    v_mfma_f32_16x16x32_bf16 v[64:67], a[112:115], v[108:111], v[64:67]
    ds_read_b128 v[100:103], v2 offset:11264
    v_fmac_f32 v93, v61, v124
    v_mfma_f32_16x16x32_bf16 v[68:71], a[116:119], v[108:111], v[68:71]
    v_fmac_f32 v94, v62, v124
    v_fmac_f32 v95, v63, v124
    v_mfma_f32_16x16x32_bf16 v[72:75], a[120:123], v[108:111], v[72:75]
    v_fma_f32 v80, v80, v126, v126
    ds_read_b64_tr_b16 v[244:245], v9 offset:53248
    v_mfma_f32_16x16x32_bf16 v[76:79], a[124:127], v[108:111], v[76:79]
    s_waitcnt lgkmcnt(6)
    v_fma_f32 v81, v81, v126, v126
    v_fma_f32 v82, v82, v126, v126
    v_mfma_f32_16x16x32_bf16 v[64:67], a[128:131], v[112:115], v[64:67]
    ds_read_b128 v[104:107], v2 offset:12288
    v_fma_f32 v83, v83, v126, v126
    v_mfma_f32_16x16x32_bf16 v[68:71], a[132:135], v[112:115], v[68:71]
    v_fma_f32 v84, v84, v126, v126
    v_fma_f32 v85, v85, v126, v126
    v_mfma_f32_16x16x32_bf16 v[72:75], a[136:139], v[112:115], v[72:75]
    v_fma_f32 v86, v86, v126, v126
    ds_read_b64_tr_b16 v[246:247], v9 offset:55296
    v_mfma_f32_16x16x32_bf16 v[76:79], a[140:143], v[112:115], v[76:79]
    s_waitcnt lgkmcnt(7)
    v_fma_f32 v87, v87, v126, v126
    ds_read_b64_tr_b16 v[248:249], v10 offset:53248
    v_mfma_f32_16x16x32_bf16 v[64:67], a[144:147], v[116:119], v[64:67]
    ds_read_b128 v[108:111], v2 offset:13312
    v_mfma_f32_16x16x32_bf16 v[68:71], a[148:151], v[116:119], v[68:71]
    v_rcp_f32 v80, v80
    v_mfma_f32_16x16x32_bf16 v[72:75], a[152:155], v[116:119], v[72:75]
    v_rcp_f32 v81, v81
    v_mfma_f32_16x16x32_bf16 v[76:79], a[156:159], v[116:119], v[76:79]
    s_waitcnt lgkmcnt(8)
    v_rcp_f32 v82, v82
    v_mfma_f32_16x16x32_bf16 v[64:67], a[160:163], v[96:99], v[64:67]
    ds_read_b128 v[112:115], v2 offset:14336
    ds_read_b64_tr_b16 v[250:251], v10 offset:55296
    v_mfma_f32_16x16x32_bf16 v[68:71], a[164:167], v[96:99], v[68:71]
    v_rcp_f32 v83, v83
    v_mfma_f32_16x16x32_bf16 v[72:75], a[168:171], v[96:99], v[72:75]
    buffer_load_dword v23, v21, s[32:35], s16 offen offset:1280 sc1
    v_mfma_f32_16x16x32_bf16 v[76:79], a[172:175], v[96:99], v[76:79]
    s_waitcnt lgkmcnt(7)
    v_rcp_f32 v84, v84
    v_mfma_f32_16x16x32_bf16 v[64:67], a[176:179], v[100:103], v[64:67]
    ds_read_b128 v[116:119], v2 offset:15360
    ds_read_b64_tr_b16 v[252:253], v11 offset:53248
    v_mfma_f32_16x16x32_bf16 v[68:71], a[180:183], v[100:103], v[68:71]
    v_rcp_f32 v85, v85
    v_mfma_f32_16x16x32_bf16 v[72:75], a[184:187], v[100:103], v[72:75]
    v_rcp_f32 v86, v86
    v_mfma_f32_16x16x32_bf16 v[76:79], a[188:191], v[100:103], v[76:79]
    s_waitcnt lgkmcnt(7)
    v_rcp_f32 v87, v87
    v_mfma_f32_16x16x32_bf16 v[64:67], a[192:195], v[104:107], v[64:67]
    ds_read_b128 v[96:99], v2 offset:16384
    v_mul_f32 v80, v80, v88
    v_mfma_f32_16x16x32_bf16 v[68:71], a[196:199], v[104:107], v[68:71]
    v_mul_f32 v81, v81, v89
    v_mul_f32 v82, v82, v90
    v_mfma_f32_16x16x32_bf16 v[72:75], a[200:203], v[104:107], v[72:75]
    v_mul_f32 v83, v83, v91
    v_mul_f32 v84, v84, v92
    v_mfma_f32_16x16x32_bf16 v[76:79], a[204:207], v[104:107], v[76:79]
    s_waitcnt lgkmcnt(5)
    v_mul_f32 v85, v85, v93
    v_mul_f32 v86, v86, v94
    v_mfma_f32_16x16x32_bf16 v[64:67], a[208:211], v[108:111], v[64:67]
    ds_read_b128 v[100:103], v2 offset:17408
    v_mul_f32 v87, v87, v95
    v_mfma_f32_16x16x32_bf16 v[68:71], a[212:215], v[108:111], v[68:71]
    ds_read_b96 v[120:122], v20 offset:1024
    v_cvt_pk_bf16_f32 v16, v80, v81
    v_mfma_f32_16x16x32_bf16 v[72:75], a[216:219], v[108:111], v[72:75]
    v_cvt_pk_bf16_f32 v17, v82, v83
    v_cvt_pk_bf16_f32 v18, v84, v85
    v_mfma_f32_16x16x32_bf16 v[76:79], a[220:223], v[108:111], v[76:79]
    s_waitcnt lgkmcnt(6)
    v_cvt_pk_bf16_f32 v19, v86, v87
    buffer_store_dwordx4 v[16:19], v2, s[32:35], s53 offen sc1
    s_add_u32 s53, s53, 57344
    v_mfma_f32_16x16x32_bf16 v[80:83], a[0:3], v[112:115], 0
    ds_read_b128 v[104:107], v2 offset:18432
    ds_read_b64_tr_b16 v[254:255], v11 offset:55296
    v_mfma_f32_16x16x32_bf16 v[84:87], a[4:7], v[112:115], 0
    s_add_u32 m0, s51, 4096
    s_nop 0
    buffer_load_dwordx4 v12, s[24:27], s50 offen offset:0 lds
    v_mfma_f32_16x16x32_bf16 v[88:91], a[8:11], v[112:115], 0
    buffer_load_dwordx4 v13, s[24:27], s50 offen offset:1024 lds
    v_mfma_f32_16x16x32_bf16 v[92:95], a[12:15], v[112:115], 0
    s_waitcnt lgkmcnt(6)
    s_waitcnt lgkmcnt(2)
    v_fmac_f32 v64, v48, v120
    v_mfma_f32_16x16x32_bf16 v[80:83], a[16:19], v[116:119], v[80:83]
    ds_read_b128 v[108:111], v2 offset:19456
    v_fmac_f32 v65, v49, v120
    v_mfma_f32_16x16x32_bf16 v[84:87], a[20:23], v[116:119], v[84:87]
    v_fmac_f32 v66, v50, v120
    v_fmac_f32 v67, v51, v120
    v_mfma_f32_16x16x32_bf16 v[88:91], a[24:27], v[116:119], v[88:91]
    v_fmac_f32 v68, v52, v120
    v_fmac_f32 v69, v53, v120
    v_mfma_f32_16x16x32_bf16 v[92:95], a[28:31], v[116:119], v[92:95]
    s_waitcnt lgkmcnt(5)
    v_fmac_f32 v70, v54, v120
    v_fmac_f32 v71, v55, v120
    v_mfma_f32_16x16x32_bf16 v[80:83], a[32:35], v[96:99], v[80:83]
    ds_read_b128 v[112:115], v2 offset:20480
    v_mul_f32 v64, v64, v121
    v_mfma_f32_16x16x32_bf16 v[84:87], a[36:39], v[96:99], v[84:87]
    v_mul_f32 v65, v65, v121
    v_mul_f32 v66, v66, v121
    v_mfma_f32_16x16x32_bf16 v[88:91], a[40:43], v[96:99], v[88:91]
    v_mul_f32 v67, v67, v121
    buffer_load_dwordx4 v14, s[24:27], s50 offen offset:2048 lds
    v_mfma_f32_16x16x32_bf16 v[92:95], a[44:47], v[96:99], v[92:95]
    s_waitcnt lgkmcnt(5)
    v_mul_f32 v68, v68, v121
    v_mul_f32 v69, v69, v121
    v_mfma_f32_16x16x32_bf16 v[80:83], a[48:51], v[100:103], v[80:83]
    ds_read_b128 v[116:119], v2 offset:21504
    v_mul_f32 v70, v70, v121
    v_mfma_f32_16x16x32_bf16 v[84:87], a[52:55], v[100:103], v[84:87]
    v_mul_f32 v71, v71, v121
    buffer_load_dwordx4 v15, s[24:27], s50 offen offset:3072 lds
    v_mfma_f32_16x16x32_bf16 v[88:91], a[56:59], v[100:103], v[88:91]
    v_exp_f32 v64, v64
    v_mfma_f32_16x16x32_bf16 v[92:95], a[60:63], v[100:103], v[92:95]
    s_waitcnt lgkmcnt(4)
    v_exp_f32 v65, v65
    v_mfma_f32_16x16x32_bf16 v[80:83], a[64:67], v[104:107], v[80:83]
    ds_read_b128 v[96:99], v2 offset:22528
    s_add_u32 s50, s50, 28672
    v_mfma_f32_16x16x32_bf16 v[84:87], a[68:71], v[104:107], v[84:87]
    v_exp_f32 v66, v66
    v_mfma_f32_16x16x32_bf16 v[88:91], a[72:75], v[104:107], v[88:91]
    v_exp_f32 v67, v67
    v_mfma_f32_16x16x32_bf16 v[92:95], a[76:79], v[104:107], v[92:95]
    s_waitcnt lgkmcnt(3)
    v_exp_f32 v68, v68
    v_mfma_f32_16x16x32_bf16 v[80:83], a[80:83], v[108:111], v[80:83]
    ds_read_b128 v[100:103], v2 offset:23552
    s_add_u32 m0, s51, 8192
    v_mfma_f32_16x16x32_bf16 v[84:87], a[84:87], v[108:111], v[84:87]
    v_exp_f32 v69, v69
    v_mfma_f32_16x16x32_bf16 v[88:91], a[88:91], v[108:111], v[88:91]
    v_exp_f32 v70, v70
    v_mfma_f32_16x16x32_bf16 v[92:95], a[92:95], v[108:111], v[92:95]
    s_waitcnt lgkmcnt(3)
    v_exp_f32 v71, v71
    v_mfma_f32_16x16x32_bf16 v[80:83], a[96:99], v[112:115], v[80:83]
    ds_read_b128 v[104:107], v2 offset:24576
    buffer_load_dwordx4 v12, s[24:27], s50 offen offset:0 lds
    v_mfma_f32_16x16x32_bf16 v[84:87], a[100:103], v[112:115], v[84:87]
    v_fmac_f32 v72, v56, v120
    v_fmac_f32 v73, v57, v120
    v_mfma_f32_16x16x32_bf16 v[88:91], a[104:107], v[112:115], v[88:91]
    v_fmac_f32 v74, v58, v120
    buffer_load_dwordx4 v13, s[24:27], s50 offen offset:1024 lds
    v_mfma_f32_16x16x32_bf16 v[92:95], a[108:111], v[112:115], v[92:95]
    s_waitcnt lgkmcnt(3)
    v_fmac_f32 v75, v59, v120
    v_fmac_f32 v76, v60, v120
    v_mfma_f32_16x16x32_bf16 v[80:83], a[112:115], v[116:119], v[80:83]
    ds_read_b128 v[108:111], v2 offset:25600
    v_fmac_f32 v77, v61, v120
    v_mfma_f32_16x16x32_bf16 v[84:87], a[116:119], v[116:119], v[84:87]
    v_fmac_f32 v78, v62, v120
    v_fmac_f32 v79, v63, v120
    v_mfma_f32_16x16x32_bf16 v[88:91], a[120:123], v[116:119], v[88:91]
    v_fma_f32 v64, v64, v122, v122
    buffer_load_dwordx4 v14, s[24:27], s50 offen offset:2048 lds
    v_mfma_f32_16x16x32_bf16 v[92:95], a[124:127], v[116:119], v[92:95]
    s_waitcnt lgkmcnt(3)
    v_fma_f32 v65, v65, v122, v122
    v_fma_f32 v66, v66, v122, v122
    v_mfma_f32_16x16x32_bf16 v[80:83], a[128:131], v[96:99], v[80:83]
    ds_read_b128 v[112:115], v2 offset:26624
    v_fma_f32 v67, v67, v122, v122
    v_mfma_f32_16x16x32_bf16 v[84:87], a[132:135], v[96:99], v[84:87]
    v_fma_f32 v68, v68, v122, v122
    v_fma_f32 v69, v69, v122, v122
    v_mfma_f32_16x16x32_bf16 v[88:91], a[136:139], v[96:99], v[88:91]
    v_fma_f32 v70, v70, v122, v122
    buffer_load_dwordx4 v15, s[24:27], s50 offen offset:3072 lds
    v_mfma_f32_16x16x32_bf16 v[92:95], a[140:143], v[96:99], v[92:95]
    s_waitcnt lgkmcnt(3)
    v_fma_f32 v71, v71, v122, v122
    s_add_u32 s50, s50, 28672
    v_mfma_f32_16x16x32_bf16 v[80:83], a[144:147], v[100:103], v[80:83]
    ds_read_b128 v[116:119], v2 offset:27648
    s_waitcnt lgkmcnt(9)
    v_mfma_f32_16x16x32_bf16 v[84:87], a[148:151], v[100:103], v[84:87]
    v_rcp_f32 v64, v64
    v_mfma_f32_16x16x32_bf16 v[88:91], a[152:155], v[100:103], v[88:91]
    v_rcp_f32 v65, v65
    v_mfma_f32_16x16x32_bf16 v[92:95], a[156:159], v[100:103], v[92:95]
    s_waitcnt lgkmcnt(3)
    v_rcp_f32 v66, v66
    v_mfma_f32_16x16x32_bf16 v[80:83], a[160:163], v[104:107], v[80:83]
    v_rcp_f32 v67, v67
    v_mfma_f32_16x16x32_bf16 v[84:87], a[164:167], v[104:107], v[84:87]
    v_rcp_f32 v68, v68
    v_mfma_f32_16x16x32_bf16 v[88:91], a[168:171], v[104:107], v[88:91]
    v_rcp_f32 v69, v69
    v_mfma_f32_16x16x32_bf16 v[92:95], a[172:175], v[104:107], v[92:95]
    s_waitcnt lgkmcnt(2)
    s_add_u32 m0, s51, 49152
    s_nop 0
    buffer_load_dwordx4 v12, s[24:27], s50 offen offset:0 lds
    v_mfma_f32_16x16x32_bf16 v[80:83], a[176:179], v[108:111], v[80:83]
    s_waitcnt vmcnt(11) lgkmcnt(0)
    s_barrier
    buffer_load_dwordx4 v13, s[24:27], s50 offen offset:1024 lds
    v_mfma_f32_16x16x32_bf16 v[84:87], a[180:183], v[108:111], v[84:87]
    ds_read_b128 v[96:99], v2 offset:28672
    buffer_load_dwordx4 v14, s[24:27], s50 offen offset:2048 lds
    v_mfma_f32_16x16x32_bf16 v[88:91], a[184:187], v[108:111], v[88:91]
    ds_read_b128 v[100:103], v2 offset:29696
    v_mfma_f32_16x16x32_bf16 v[92:95], a[188:191], v[108:111], v[92:95]
    s_waitcnt lgkmcnt(3)
    v_rcp_f32 v70, v70
    v_mfma_f32_16x16x32_bf16 v[80:83], a[192:195], v[112:115], v[80:83]
    ds_read_b128 v[104:107], v2 offset:30720
    buffer_load_dwordx4 v15, s[24:27], s50 offen offset:3072 lds
    v_mfma_f32_16x16x32_bf16 v[84:87], a[196:199], v[112:115], v[84:87]
    v_rcp_f32 v71, v71
    v_mfma_f32_16x16x32_bf16 v[88:91], a[200:203], v[112:115], v[88:91]
    s_waitcnt vmcnt(12)
    s_cmp_eq_u32 s38, 0
    s_cbranch_scc1 sequential_preLN__softmax_full_mha__glu_gated_glu__prompt_kernel_sb12a
    buffer_store_dword v30, v31, s[36:39], s58 offen offset:0
sequential_preLN__softmax_full_mha__glu_gated_glu__prompt_kernel_sb12b:
    v_mfma_f32_16x16x32_bf16 v[92:95], a[204:207], v[112:115], v[92:95]
    s_waitcnt lgkmcnt(3)
    v_mul_f32 v64, v64, v72
    v_mul_f32 v65, v65, v73
    v_mfma_f32_16x16x32_bf16 v[80:83], a[208:211], v[116:119], v[80:83]
    ds_read_b128 v[108:111], v2 offset:31744
    v_mul_f32 v66, v66, v74
    v_mfma_f32_16x16x32_bf16 v[84:87], a[212:215], v[116:119], v[84:87]
    ds_read_b96 v[124:126], v20 offset:1280
    v_mul_f32 v67, v67, v75
    v_mfma_f32_16x16x32_bf16 v[88:91], a[216:219], v[116:119], v[88:91]
    v_mul_f32 v68, v68, v76
    v_mul_f32 v69, v69, v77
    v_mfma_f32_16x16x32_bf16 v[92:95], a[220:223], v[116:119], v[92:95]
    s_waitcnt lgkmcnt(4)
    v_mul_f32 v70, v70, v78
    v_mul_f32 v71, v71, v79
    v_cvt_pk_bf16_f32 v16, v64, v65
    v_cvt_pk_bf16_f32 v17, v66, v67
    v_cvt_pk_bf16_f32 v18, v68, v69
    v_cvt_pk_bf16_f32 v19, v70, v71
    buffer_store_dwordx4 v[16:19], v2, s[32:35], s53 offen sc1
    s_add_u32 s53, s53, 57344
    v_mfma_f32_16x16x32_bf16 v[64:67], a[0:3], v[96:99], 0
    ds_read_b128 v[112:115], v2 offset:32768
    s_add_u32 s50, s50, 28672
    v_mfma_f32_16x16x32_bf16 v[68:71], a[4:7], v[96:99], 0
    s_add_u32 m0, s51, 53248
    s_nop 0
    buffer_load_dwordx4 v12, s[24:27], s50 offen offset:0 lds
    buffer_load_dwordx4 v13, s[24:27], s50 offen offset:1024 lds
    v_mfma_f32_16x16x32_bf16 v[72:75], a[8:11], v[96:99], 0
    v_mfma_f32_16x16x32_bf16 v[76:79], a[12:15], v[96:99], 0
    s_waitcnt lgkmcnt(4)
    s_waitcnt lgkmcnt(1)
    v_fmac_f32 v80, v48, v124
    v_mfma_f32_16x16x32_bf16 v[64:67], a[16:19], v[100:103], v[64:67]
    ds_read_b128 v[116:119], v2 offset:33792
    v_fmac_f32 v81, v49, v124
    v_mfma_f32_16x16x32_bf16 v[68:71], a[20:23], v[100:103], v[68:71]
    v_fmac_f32 v82, v50, v124
    v_fmac_f32 v83, v51, v124
    v_mfma_f32_16x16x32_bf16 v[72:75], a[24:27], v[100:103], v[72:75]
    v_fmac_f32 v84, v52, v124
    v_fmac_f32 v85, v53, v124
    v_mfma_f32_16x16x32_bf16 v[76:79], a[28:31], v[100:103], v[76:79]
    s_waitcnt lgkmcnt(4)
    s_waitcnt vmcnt(17)
    v_cmp_ne_u32 vcc, s44, v23
    v_mfma_f32_16x16x32_bf16 v[64:67], a[32:35], v[104:107], v[64:67]
    ds_read_b128 v[96:99], v2 offset:34816
    s_cbranch_vccnz sequential_preLN__softmax_full_mha__glu_gated_glu__prompt_kernel_f0r
sequential_preLN__softmax_full_mha__glu_gated_glu__prompt_kernel_f0d:
    v_mfma_f32_16x16x32_bf16 v[68:71], a[36:39], v[104:107], v[68:71]
    v_fmac_f32 v86, v54, v124
    v_fmac_f32 v87, v55, v124
    v_mfma_f32_16x16x32_bf16 v[72:75], a[40:43], v[104:107], v[72:75]
    buffer_load_dwordx4 a[224:227], v2, s[32:35], s12 offen offset:0 sc1
    v_mul_f32 v80, v80, v125
    v_mfma_f32_16x16x32_bf16 v[76:79], a[44:47], v[104:107], v[76:79]
    s_waitcnt lgkmcnt(4)
    v_mul_f32 v81, v81, v125
    v_mul_f32 v82, v82, v125
    v_mfma_f32_16x16x32_bf16 v[64:67], a[48:51], v[108:111], v[64:67]
    ds_read_b128 v[100:103], v2 offset:35840
    v_mul_f32 v83, v83, v125
    v_mfma_f32_16x16x32_bf16 v[68:71], a[52:55], v[108:111], v[68:71]
    v_mul_f32 v84, v84, v125
    v_mul_f32 v85, v85, v125
    v_mfma_f32_16x16x32_bf16 v[72:75], a[56:59], v[108:111], v[72:75]
    v_mul_f32 v86, v86, v125
    v_mul_f32 v87, v87, v125
    buffer_load_dwordx4 v14, s[24:27], s50 offen offset:2048 lds
    buffer_load_dwordx4 v15, s[24:27], s50 offen offset:3072 lds
    s_add_u32 s50, s50, 28672
    v_mfma_f32_16x16x32_bf16 v[76:79], a[60:63], v[108:111], v[76:79]
    s_waitcnt lgkmcnt(3)
    buffer_load_dwordx4 a[228:231], v2, s[32:35], s12 offen offset:1024 sc1
    v_mfma_f32_16x16x32_bf16 v[64:67], a[64:67], v[112:115], v[64:67]
    ds_read_b128 v[104:107], v2 offset:36864
    v_mfma_f32_16x16x32_bf16 v[68:71], a[68:71], v[112:115], v[68:71]
    v_exp_f32 v80, v80
    v_mfma_f32_16x16x32_bf16 v[72:75], a[72:75], v[112:115], v[72:75]
    v_exp_f32 v81, v81
    v_mfma_f32_16x16x32_bf16 v[76:79], a[76:79], v[112:115], v[76:79]
    s_waitcnt lgkmcnt(3)
    v_exp_f32 v82, v82
    v_mfma_f32_16x16x32_bf16 v[64:67], a[80:83], v[116:119], v[64:67]
    ds_read_b128 v[108:111], v2 offset:37888
    buffer_load_dwordx4 a[232:235], v2, s[32:35], s12 offen offset:2048 sc1
    v_mfma_f32_16x16x32_bf16 v[68:71], a[84:87], v[116:119], v[68:71]
sequential_preLN__softmax_full_mha__glu_gated_glu__prompt_kernel_pg7:
    s_cbranch_execz sequential_preLN__softmax_full_mha__glu_gated_glu__prompt_kernel_tb5
    v_exp_f32 v83, v83
    v_mfma_f32_16x16x32_bf16 v[72:75], a[88:91], v[116:119], v[72:75]
    v_exp_f32 v84, v84
    v_mfma_f32_16x16x32_bf16 v[76:79], a[92:95], v[116:119], v[76:79]
    s_waitcnt lgkmcnt(3)
    v_exp_f32 v85, v85
    v_mfma_f32_16x16x32_bf16 v[64:67], a[96:99], v[96:99], v[64:67]
    ds_read_b128 v[112:115], v2 offset:38912
    v_mfma_f32_16x16x32_bf16 v[68:71], a[100:103], v[96:99], v[68:71]
    buffer_load_dwordx4 a[236:239], v2, s[32:35], s12 offen offset:3072 sc1
    v_mfma_f32_16x16x32_bf16 v[72:75], a[104:107], v[96:99], v[72:75]
    v_exp_f32 v86, v86
    v_mfma_f32_16x16x32_bf16 v[76:79], a[108:111], v[96:99], v[76:79]
    s_waitcnt lgkmcnt(3)
    v_exp_f32 v87, v87
    v_mfma_f32_16x16x32_bf16 v[64:67], a[112:115], v[100:103], v[64:67]
    ds_read_b128 v[116:119], v2 offset:39936
    v_fmac_f32 v88, v56, v124
    v_mfma_f32_16x16x32_bf16 v[68:71], a[116:119], v[100:103], v[68:71]
    s_add_u32 s12, s12, 4096
    v_fmac_f32 v89, v57, v124
    v_fmac_f32 v90, v58, v124
    v_mfma_f32_16x16x32_bf16 v[72:75], a[120:123], v[100:103], v[72:75]
    buffer_load_dwordx4 a[240:243], v2, s[32:35], s12 offen offset:0 sc1
    v_fmac_f32 v91, v59, v124
    v_mfma_f32_16x16x32_bf16 v[76:79], a[124:127], v[100:103], v[76:79]
    s_waitcnt lgkmcnt(3)
    v_fmac_f32 v92, v60, v124
    v_fmac_f32 v93, v61, v124
    v_mfma_f32_16x16x32_bf16 v[64:67], a[128:131], v[104:107], v[64:67]
    ds_read_b128 v[96:99], v2 offset:40960
    v_fmac_f32 v94, v62, v124
    v_mfma_f32_16x16x32_bf16 v[68:71], a[132:135], v[104:107], v[68:71]
    v_fmac_f32 v95, v63, v124
    v_fma_f32 v80, v80, v126, v126
    v_mfma_f32_16x16x32_bf16 v[72:75], a[136:139], v[104:107], v[72:75]
    v_fma_f32 v81, v81, v126, v126
    v_fma_f32 v82, v82, v126, v126
    v_mfma_f32_16x16x32_bf16 v[76:79], a[140:143], v[104:107], v[76:79]
    s_waitcnt lgkmcnt(3)
    buffer_load_dwordx4 a[244:247], v2, s[32:35], s12 offen offset:1024 sc1
    v_fma_f32 v83, v83, v126, v126
    v_mfma_f32_16x16x32_bf16 v[64:67], a[144:147], v[108:111], v[64:67]
    ds_read_b128 v[100:103], v2 offset:41984
    v_fma_f32 v84, v84, v126, v126
    v_mfma_f32_16x16x32_bf16 v[68:71], a[148:151], v[108:111], v[68:71]
    v_fma_f32 v85, v85, v126, v126
    v_fma_f32 v86, v86, v126, v126
    v_mfma_f32_16x16x32_bf16 v[72:75], a[152:155], v[108:111], v[72:75]
    v_fma_f32 v87, v87, v126, v126
    v_mfma_f32_16x16x32_bf16 v[76:79], a[156:159], v[108:111], v[76:79]
    s_waitcnt lgkmcnt(3)
    v_rcp_f32 v80, v80
    v_mfma_f32_16x16x32_bf16 v[64:67], a[160:163], v[112:115], v[64:67]
    ds_read_b128 v[104:107], v2 offset:43008
    buffer_load_dwordx4 a[248:251], v2, s[32:35], s12 offen offset:2048 sc1
    v_mfma_f32_16x16x32_bf16 v[68:71], a[164:167], v[112:115], v[68:71]
    v_rcp_f32 v81, v81
    v_mfma_f32_16x16x32_bf16 v[72:75], a[168:171], v[112:115], v[72:75]
    v_rcp_f32 v82, v82
    v_mfma_f32_16x16x32_bf16 v[76:79], a[172:175], v[112:115], v[76:79]
    s_waitcnt lgkmcnt(3)
    v_rcp_f32 v83, v83
    v_mfma_f32_16x16x32_bf16 v[64:67], a[176:179], v[116:119], v[64:67]
    ds_read_b128 v[108:111], v2 offset:44032
    v_mfma_f32_16x16x32_bf16 v[68:71], a[180:183], v[116:119], v[68:71]
    buffer_load_dwordx4 a[252:255], v2, s[32:35], s12 offen offset:3072 sc1
    v_mfma_f32_16x16x32_bf16 v[72:75], a[184:187], v[116:119], v[72:75]
    v_rcp_f32 v84, v84
    v_mfma_f32_16x16x32_bf16 v[76:79], a[188:191], v[116:119], v[76:79]
    s_waitcnt lgkmcnt(3)
    v_rcp_f32 v85, v85
    v_mfma_f32_16x16x32_bf16 v[64:67], a[192:195], v[96:99], v[64:67]
    ds_read_b128 v[112:115], v2 offset:45056
    v_mfma_f32_16x16x32_bf16 v[68:71], a[196:199], v[96:99], v[68:71]
    v_rcp_f32 v86, v86
    v_mfma_f32_16x16x32_bf16 v[72:75], a[200:203], v[96:99], v[72:75]
    buffer_load_dword v23, v22, s[32:35], s17 offen offset:0 sc1
    v_mfma_f32_16x16x32_bf16 v[76:79], a[204:207], v[96:99], v[76:79]
    s_waitcnt lgkmcnt(3)
    v_rcp_f32 v87, v87
    v_mfma_f32_16x16x32_bf16 v[64:67], a[208:211], v[100:103], v[64:67]
    ds_read_b128 v[116:119], v2 offset:46080
    v_mul_f32 v80, v80, v88
    v_mfma_f32_16x16x32_bf16 v[68:71], a[212:215], v[100:103], v[68:71]
    ds_read_b96 v[120:122], v20 offset:1536
    v_mul_f32 v81, v81, v89
    v_mfma_f32_16x16x32_bf16 v[72:75], a[216:219], v[100:103], v[72:75]
    v_mul_f32 v82, v82, v90
    v_mul_f32 v83, v83, v91
    v_mfma_f32_16x16x32_bf16 v[76:79], a[220:223], v[100:103], v[76:79]
    s_waitcnt lgkmcnt(4)
    v_mul_f32 v84, v84, v92
    v_mul_f32 v85, v85, v93
    v_mul_f32 v86, v86, v94
    v_mul_f32 v87, v87, v95
    v_cvt_pk_bf16_f32 v16, v80, v81
    v_cvt_pk_bf16_f32 v17, v82, v83
    v_cvt_pk_bf16_f32 v18, v84, v85
    v_cvt_pk_bf16_f32 v19, v86, v87
    buffer_store_dwordx4 v[16:19], v2, s[32:35], s53 offen sc1
    s_add_u32 s53, s53, s62
    v_mfma_f32_16x16x32_bf16 v[80:83], a[0:3], v[104:107], 0
    ds_read_b128 v[96:99], v2 offset:47104
    v_mfma_f32_16x16x32_bf16 v[84:87], a[4:7], v[104:107], 0
    v_mfma_f32_16x16x32_bf16 v[88:91], a[8:11], v[104:107], 0
    v_mfma_f32_16x16x32_bf16 v[92:95], a[12:15], v[104:107], 0
    s_waitcnt lgkmcnt(4)
    s_add_u32 s12, s12, 4096
    s_waitcnt lgkmcnt(1)
    v_mfma_f32_16x16x32_bf16 v[80:83], a[16:19], v[108:111], v[80:83]
    ds_read_b128 v[100:103], v2 offset:48128
    buffer_load_dwordx4 a[0:3], v2, s[32:35], s12 offen offset:0 sc1
    v_mfma_f32_16x16x32_bf16 v[84:87], a[20:23], v[108:111], v[84:87]
    v_fmac_f32 v64, v48, v120
    v_fmac_f32 v65, v49, v120
    v_mfma_f32_16x16x32_bf16 v[88:91], a[24:27], v[108:111], v[88:91]
    v_fmac_f32 v66, v50, v120
    v_fmac_f32 v67, v51, v120
    v_mfma_f32_16x16x32_bf16 v[92:95], a[28:31], v[108:111], v[92:95]
    s_waitcnt lgkmcnt(4)
    v_fmac_f32 v68, v52, v120
    v_fmac_f32 v69, v53, v120
    v_mfma_f32_16x16x32_bf16 v[80:83], a[32:35], v[112:115], v[80:83]
    ds_read_b128 v[104:107], v2 offset:49152
    buffer_load_dwordx4 a[4:7], v2, s[32:35], s12 offen offset:1024 sc1
    v_mfma_f32_16x16x32_bf16 v[84:87], a[36:39], v[112:115], v[84:87]
    v_fmac_f32 v70, v54, v120
    v_fmac_f32 v71, v55, v120
    v_mfma_f32_16x16x32_bf16 v[88:91], a[40:43], v[112:115], v[88:91]
    v_mul_f32 v64, v64, v121
    v_mul_f32 v65, v65, v121
    v_mfma_f32_16x16x32_bf16 v[92:95], a[44:47], v[112:115], v[92:95]
    s_waitcnt lgkmcnt(4)
    v_mul_f32 v66, v66, v121
    v_mul_f32 v67, v67, v121
    v_mfma_f32_16x16x32_bf16 v[80:83], a[48:51], v[116:119], v[80:83]
    ds_read_b128 v[108:111], v2 offset:50176
    buffer_load_dwordx4 a[8:11], v2, s[32:35], s12 offen offset:2048 sc1
    v_mfma_f32_16x16x32_bf16 v[84:87], a[52:55], v[116:119], v[84:87]
    v_mul_f32 v68, v68, v121
    v_mul_f32 v69, v69, v121
    v_mfma_f32_16x16x32_bf16 v[88:91], a[56:59], v[116:119], v[88:91]
    v_mul_f32 v70, v70, v121
    v_mul_f32 v71, v71, v121
    v_mfma_f32_16x16x32_bf16 v[92:95], a[60:63], v[116:119], v[92:95]
    s_waitcnt lgkmcnt(3)
    v_exp_f32 v64, v64
    v_mfma_f32_16x16x32_bf16 v[80:83], a[64:67], v[96:99], v[80:83]
    ds_read_b128 v[112:115], v2 offset:51200
    v_mfma_f32_16x16x32_bf16 v[84:87], a[68:71], v[96:99], v[84:87]
    buffer_load_dwordx4 a[12:15], v2, s[32:35], s12 offen offset:3072 sc1
    v_mfma_f32_16x16x32_bf16 v[88:91], a[72:75], v[96:99], v[88:91]
    v_exp_f32 v65, v65
    v_mfma_f32_16x16x32_bf16 v[92:95], a[76:79], v[96:99], v[92:95]
    s_waitcnt lgkmcnt(3)
    v_exp_f32 v66, v66
    v_mfma_f32_16x16x32_bf16 v[80:83], a[80:83], v[100:103], v[80:83]
    ds_read_b128 v[116:119], v2 offset:52224
    s_add_u32 s12, s12, 4096
    v_mfma_f32_16x16x32_bf16 v[84:87], a[84:87], v[100:103], v[84:87]
    buffer_load_dwordx4 a[16:19], v2, s[32:35], s12 offen offset:0 sc1
    v_mfma_f32_16x16x32_bf16 v[88:91], a[88:91], v[100:103], v[88:91]
    v_exp_f32 v67, v67
    v_mfma_f32_16x16x32_bf16 v[92:95], a[92:95], v[100:103], v[92:95]
    s_waitcnt lgkmcnt(3)
    v_exp_f32 v68, v68
    v_mfma_f32_16x16x32_bf16 v[80:83], a[96:99], v[104:107], v[80:83]
    ds_read_b128 v[96:99], v2 offset:53248
    v_mfma_f32_16x16x32_bf16 v[84:87], a[100:103], v[104:107], v[84:87]
    v_exp_f32 v69, v69
    v_mfma_f32_16x16x32_bf16 v[88:91], a[104:107], v[104:107], v[88:91]
    buffer_load_dwordx4 a[20:23], v2, s[32:35], s12 offen offset:1024 sc1
    v_mfma_f32_16x16x32_bf16 v[92:95], a[108:111], v[104:107], v[92:95]
    s_waitcnt lgkmcnt(3)
    v_exp_f32 v70, v70
    v_mfma_f32_16x16x32_bf16 v[80:83], a[112:115], v[108:111], v[80:83]
    ds_read_b128 v[100:103], v2 offset:54272
    v_mfma_f32_16x16x32_bf16 v[84:87], a[116:119], v[108:111], v[84:87]
    s_waitcnt vmcnt(7)
    v_cmp_ne_u32 vcc, s44, v23
    v_mfma_f32_16x16x32_bf16 v[88:91], a[120:123], v[108:111], v[88:91]
    s_cbranch_vccnz sequential_preLN__softmax_full_mha__glu_gated_glu__prompt_kernel_f1r
sequential_preLN__softmax_full_mha__glu_gated_glu__prompt_kernel_f1d:
    v_exp_f32 v71, v71
    v_mfma_f32_16x16x32_bf16 v[92:95], a[124:127], v[108:111], v[92:95]
    s_waitcnt lgkmcnt(3)
    v_fmac_f32 v72, v56, v120
    v_fmac_f32 v73, v57, v120
    v_mfma_f32_16x16x32_bf16 v[80:83], a[128:131], v[112:115], v[80:83]
    ds_read_b128 v[104:107], v2 offset:55296
    buffer_load_dwordx4 a[24:27], v2, s[32:35], s13 offen offset:0 sc1
    v_mfma_f32_16x16x32_bf16 v[84:87], a[132:135], v[112:115], v[84:87]
    v_fmac_f32 v74, v58, v120
    v_fmac_f32 v75, v59, v120
    v_mfma_f32_16x16x32_bf16 v[88:91], a[136:139], v[112:115], v[88:91]
    v_fmac_f32 v76, v60, v120
    v_fmac_f32 v77, v61, v120
    v_mfma_f32_16x16x32_bf16 v[92:95], a[140:143], v[112:115], v[92:95]
    s_waitcnt lgkmcnt(3)
    v_fmac_f32 v78, v62, v120
    v_fmac_f32 v79, v63, v120
    v_mfma_f32_16x16x32_bf16 v[80:83], a[144:147], v[116:119], v[80:83]
    ds_read_b128 v[108:111], v2 offset:56320
    buffer_load_dwordx4 a[28:31], v2, s[32:35], s13 offen offset:1024 sc1
    v_mfma_f32_16x16x32_bf16 v[84:87], a[148:151], v[116:119], v[84:87]
    v_fma_f32 v64, v64, v122, v122
    v_fma_f32 v65, v65, v122, v122
    v_mfma_f32_16x16x32_bf16 v[88:91], a[152:155], v[116:119], v[88:91]
    v_fma_f32 v66, v66, v122, v122
    v_fma_f32 v67, v67, v122, v122
    v_mfma_f32_16x16x32_bf16 v[92:95], a[156:159], v[116:119], v[92:95]
    s_waitcnt lgkmcnt(3)
    v_fma_f32 v68, v68, v122, v122
    v_fma_f32 v69, v69, v122, v122
    v_mfma_f32_16x16x32_bf16 v[80:83], a[160:163], v[96:99], v[80:83]
    buffer_load_dwordx4 a[32:35], v2, s[32:35], s13 offen offset:2048 sc1
    v_fma_f32 v70, v70, v122, v122
    v_mfma_f32_16x16x32_bf16 v[84:87], a[164:167], v[96:99], v[84:87]
    v_fma_f32 v71, v71, v122, v122
    v_mfma_f32_16x16x32_bf16 v[88:91], a[168:171], v[96:99], v[88:91]
    s_waitcnt vmcnt(9)
    s_cmp_eq_u32 s38, 0
    s_cbranch_scc1 sequential_preLN__softmax_full_mha__glu_gated_glu__prompt_kernel_sb13a
    buffer_store_dword v30, v31, s[36:39], s58 offen offset:1024
sequential_preLN__softmax_full_mha__glu_gated_glu__prompt_kernel_sb13b:
    v_mfma_f32_16x16x32_bf16 v[92:95], a[172:175], v[96:99], v[92:95]
    s_waitcnt lgkmcnt(2)
    v_rcp_f32 v64, v64
    v_mfma_f32_16x16x32_bf16 v[80:83], a[176:179], v[100:103], v[80:83]
    v_rcp_f32 v65, v65
    v_mfma_f32_16x16x32_bf16 v[84:87], a[180:183], v[100:103], v[84:87]
    buffer_load_dwordx4 a[36:39], v2, s[32:35], s13 offen offset:3072 sc1
    v_mfma_f32_16x16x32_bf16 v[88:91], a[184:187], v[100:103], v[88:91]
    v_rcp_f32 v66, v66
    v_mfma_f32_16x16x32_bf16 v[92:95], a[188:191], v[100:103], v[92:95]
    s_waitcnt lgkmcnt(1)
    v_rcp_f32 v67, v67
    v_mfma_f32_16x16x32_bf16 v[80:83], a[192:195], v[104:107], v[80:83]
    s_add_u32 s13, s13, 4096
    v_rcp_f32 v68, v68
    v_mfma_f32_16x16x32_bf16 v[84:87], a[196:199], v[104:107], v[84:87]
    buffer_load_dwordx4 a[40:43], v2, s[32:35], s13 offen offset:0 sc1
    v_mfma_f32_16x16x32_bf16 v[88:91], a[200:203], v[104:107], v[88:91]
    v_rcp_f32 v69, v69
    v_mfma_f32_16x16x32_bf16 v[92:95], a[204:207], v[104:107], v[92:95]
    s_waitcnt lgkmcnt(0)
    v_rcp_f32 v70, v70
    v_mfma_f32_16x16x32_bf16 v[80:83], a[208:211], v[108:111], v[80:83]
    v_rcp_f32 v71, v71
    v_mfma_f32_16x16x32_bf16 v[84:87], a[212:215], v[108:111], v[84:87]
    ds_read_b96 v[124:126], v20 offset:1792
    v_mul_f32 v64, v64, v72
    v_mfma_f32_16x16x32_bf16 v[88:91], a[216:219], v[108:111], v[88:91]
    buffer_load_dwordx4 a[44:47], v2, s[32:35], s13 offen offset:1024 sc1
    v_mul_f32 v65, v65, v73
    v_mfma_f32_16x16x32_bf16 v[92:95], a[220:223], v[108:111], v[92:95]
    s_waitcnt vmcnt(24)
    v_mul_f32 v66, v66, v74
    v_mul_f32 v67, v67, v75
    v_mul_f32 v68, v68, v76
    v_mul_f32 v69, v69, v77
    v_mul_f32 v70, v70, v78
    v_mul_f32 v71, v71, v79
    v_cvt_pk_bf16_f32 v16, v64, v65
    v_cvt_pk_bf16_f32 v17, v66, v67
    v_cvt_pk_bf16_f32 v18, v68, v69
    v_cvt_pk_bf16_f32 v19, v70, v71
    s_cmp_eq_u32 s38, 0
    s_cbranch_scc1 sequential_preLN__softmax_full_mha__glu_gated_glu__prompt_kernel_sb11a
    buffer_store_dwordx4 v[16:19], v2, s[36:39], s53 offen offset:0
sequential_preLN__softmax_full_mha__glu_gated_glu__prompt_kernel_sb11b:
    s_add_u32 s53, s53, 57344
    v_mfma_f32_16x16x32_bf16 v[64:67], v[128:131], a[224:227], 0
    v_mfma_f32_16x16x32_bf16 v[68:71], v[132:135], a[224:227], 0
    v_mfma_f32_16x16x32_bf16 v[72:75], v[136:139], a[224:227], 0
    buffer_load_dwordx4 a[48:51], v2, s[32:35], s13 offen offset:2048 sc1
    v_mfma_f32_16x16x32_bf16 v[76:79], v[140:143], a[224:227], 0
    s_waitcnt vmcnt(23)
    s_waitcnt lgkmcnt(0)
    v_fmac_f32 v80, v48, v124
    v_mfma_f32_16x16x32_bf16 v[64:67], v[144:147], a[228:231], v[64:67]
    v_fmac_f32 v81, v49, v124
    v_fmac_f32 v82, v50, v124
    v_mfma_f32_16x16x32_bf16 v[68:71], v[148:151], a[228:231], v[68:71]
    v_fmac_f32 v83, v51, v124
    v_fmac_f32 v84, v52, v124
    v_mfma_f32_16x16x32_bf16 v[72:75], v[152:155], a[228:231], v[72:75]
    buffer_load_dwordx4 a[52:55], v2, s[32:35], s13 offen offset:3072 sc1
    v_fmac_f32 v85, v53, v124
    v_mfma_f32_16x16x32_bf16 v[76:79], v[156:159], a[228:231], v[76:79]
    s_waitcnt vmcnt(23)
    v_fmac_f32 v86, v54, v124
    v_fmac_f32 v87, v55, v124
    v_mfma_f32_16x16x32_bf16 v[64:67], v[160:163], a[232:235], v[64:67]
    v_mul_f32 v80, v80, v125
    v_mul_f32 v81, v81, v125
    v_mfma_f32_16x16x32_bf16 v[68:71], v[164:167], a[232:235], v[68:71]
    v_mul_f32 v82, v82, v125
    v_mul_f32 v83, v83, v125
    v_mfma_f32_16x16x32_bf16 v[72:75], v[168:171], a[232:235], v[72:75]
    s_add_u32 s13, s13, 4096
    v_mul_f32 v84, v84, v125
    v_mul_f32 v85, v85, v125
    v_mfma_f32_16x16x32_bf16 v[76:79], v[172:175], a[232:235], v[76:79]
    s_waitcnt vmcnt(22)
    buffer_load_dwordx4 a[56:59], v2, s[32:35], s13 offen offset:0 sc1
    v_mul_f32 v86, v86, v125
    v_mfma_f32_16x16x32_bf16 v[64:67], v[176:179], a[236:239], v[64:67]
    v_mul_f32 v87, v87, v125
    v_mfma_f32_16x16x32_bf16 v[68:71], v[180:183], a[236:239], v[68:71]
    v_exp_f32 v80, v80
    v_mfma_f32_16x16x32_bf16 v[72:75], v[184:187], a[236:239], v[72:75]
    v_exp_f32 v81, v81
    v_mfma_f32_16x16x32_bf16 v[76:79], v[188:191], a[236:239], v[76:79]
    s_waitcnt vmcnt(22)
    buffer_load_dwordx4 a[60:63], v2, s[32:35], s13 offen offset:1024 sc1
    v_mfma_f32_16x16x32_bf16 v[64:67], v[192:195], a[240:243], v[64:67]
    v_exp_f32 v82, v82
    v_mfma_f32_16x16x32_bf16 v[68:71], v[196:199], a[240:243], v[68:71]
    v_exp_f32 v83, v83
    v_mfma_f32_16x16x32_bf16 v[72:75], v[200:203], a[240:243], v[72:75]
    buffer_load_dword v23, v21, s[32:35], s16 offen offset:1024 sc1
    v_mfma_f32_16x16x32_bf16 v[76:79], v[204:207], a[240:243], v[76:79]
    s_waitcnt vmcnt(23)
    v_exp_f32 v84, v84
    v_mfma_f32_16x16x32_bf16 v[64:67], v[208:211], a[244:247], v[64:67]
    buffer_load_dwordx4 a[64:67], v2, s[32:35], s13 offen offset:2048 sc1
    v_mfma_f32_16x16x32_bf16 v[68:71], v[212:215], a[244:247], v[68:71]
    v_exp_f32 v85, v85
    v_mfma_f32_16x16x32_bf16 v[72:75], v[216:219], a[244:247], v[72:75]
    v_exp_f32 v86, v86
    v_mfma_f32_16x16x32_bf16 v[76:79], v[220:223], a[244:247], v[76:79]
    s_waitcnt vmcnt(23) lgkmcnt(15)
    v_exp_f32 v87, v87
    v_mfma_f32_16x16x32_bf16 v[64:67], v[224:227], a[248:251], v[64:67]
    buffer_load_dwordx4 a[68:71], v2, s[32:35], s13 offen offset:3072 sc1
    v_fmac_f32 v88, v56, v124
    v_mfma_f32_16x16x32_bf16 v[68:71], v[228:231], a[248:251], v[68:71]
    v_fmac_f32 v89, v57, v124
    v_fmac_f32 v90, v58, v124
    v_mfma_f32_16x16x32_bf16 v[72:75], v[232:235], a[248:251], v[72:75]
    v_fmac_f32 v91, v59, v124
    v_fmac_f32 v92, v60, v124
    v_mfma_f32_16x16x32_bf16 v[76:79], v[236:239], a[248:251], v[76:79]
    s_waitcnt vmcnt(23) lgkmcnt(15)
    s_add_u32 s13, s13, 4096
    v_fmac_f32 v93, v61, v124
    v_mfma_f32_16x16x32_bf16 v[64:67], v[240:243], a[252:255], v[64:67]
    buffer_load_dwordx4 a[72:75], v2, s[32:35], s13 offen offset:0 sc1
    v_fmac_f32 v94, v62, v124
    v_mfma_f32_16x16x32_bf16 v[68:71], v[244:247], a[252:255], v[68:71]
    v_fmac_f32 v95, v63, v124
    v_fma_f32 v80, v80, v126, v126
    v_mfma_f32_16x16x32_bf16 v[72:75], v[248:251], a[252:255], v[72:75]
    v_fma_f32 v81, v81, v126, v126
    v_fma_f32 v82, v82, v126, v126
    v_mfma_f32_16x16x32_bf16 v[76:79], v[252:255], a[252:255], v[76:79]
    s_waitcnt vmcnt(15)
    v_fma_f32 v83, v83, v126, v126
    v_fma_f32 v84, v84, v126, v126
    v_mfma_f32_16x16x32_bf16 v[96:99], v[128:131], a[24:27], 0
    v_fma_f32 v85, v85, v126, v126
    v_fma_f32 v86, v86, v126, v126
    v_mfma_f32_16x16x32_bf16 v[100:103], v[132:135], a[24:27], 0
    buffer_load_dwordx4 a[76:79], v2, s[32:35], s13 offen offset:1024 sc1
    v_fma_f32 v87, v87, v126, v126
    v_mfma_f32_16x16x32_bf16 v[32:35], v[136:139], a[24:27], v[32:35]
    v_rcp_f32 v80, v80
    v_mfma_f32_16x16x32_bf16 v[36:39], v[140:143], a[24:27], v[36:39]
    s_waitcnt vmcnt(15)
    v_rcp_f32 v81, v81
    v_mfma_f32_16x16x32_bf16 v[96:99], v[144:147], a[28:31], v[96:99]
    v_rcp_f32 v82, v82
    v_mfma_f32_16x16x32_bf16 v[100:103], v[148:151], a[28:31], v[100:103]
    v_rcp_f32 v83, v83
    v_mfma_f32_16x16x32_bf16 v[32:35], v[152:155], a[28:31], v[32:35]
    v_rcp_f32 v84, v84
    v_mfma_f32_16x16x32_bf16 v[36:39], v[156:159], a[28:31], v[36:39]
    s_waitcnt vmcnt(14)
    v_rcp_f32 v85, v85
    v_mfma_f32_16x16x32_bf16 v[96:99], v[160:163], a[32:35], v[96:99]
    v_rcp_f32 v86, v86
    v_rcp_f32 v87, v87
    v_mul_f32 v80, v80, v88
    v_mul_f32 v81, v81, v89
    v_mul_f32 v82, v82, v90
    v_mul_f32 v83, v83, v91
    v_mul_f32 v84, v84, v92
    v_mul_f32 v85, v85, v93
    v_mul_f32 v86, v86, v94
    v_mul_f32 v87, v87, v95
    v_cvt_pk_bf16_f32 v16, v80, v81
    v_cvt_pk_bf16_f32 v17, v82, v83
    v_cvt_pk_bf16_f32 v18, v84, v85
    v_cvt_pk_bf16_f32 v19, v86, v87
    s_cmp_eq_u32 s38, 0
    s_cbranch_scc1 sequential_preLN__softmax_full_mha__glu_gated_glu__prompt_kernel_sb15a
    buffer_store_dwordx4 v[16:19], v2, s[36:39], s53 offen offset:0
sequential_preLN__softmax_full_mha__glu_gated_glu__prompt_kernel_sb15b:
    s_add_u32 s53, s53, 57344
    v_mfma_f32_16x16x32_bf16 v[100:103], v[164:167], a[32:35], v[100:103]
    s_waitcnt vmcnt(5)
    v_cmp_ne_u32 vcc, s44, v23
    s_waitcnt vmcnt(33)
    v_mfma_f32_16x16x32_bf16 v[32:35], v[168:171], a[32:35], v[32:35]
    s_cbranch_vccnz sequential_preLN__softmax_full_mha__glu_gated_glu__prompt_kernel_f3r
sequential_preLN__softmax_full_mha__glu_gated_glu__prompt_kernel_f3d:
    ds_read_b64_tr_b16 a[128:129], v8 offset:57344
    ds_read_b64_tr_b16 a[130:131], v8 offset:59392
    v_mfma_f32_16x16x32_bf16 v[36:39], v[172:175], a[32:35], v[36:39]
    s_waitcnt vmcnt(13)
    ds_read_b64_tr_b16 a[132:133], v9 offset:57344
    ds_read_b64_tr_b16 a[134:135], v9 offset:59392
    v_mfma_f32_16x16x32_bf16 v[96:99], v[176:179], a[36:39], v[96:99]
    buffer_load_dwordx4 a[80:83], v2, s[32:35], s14 offen offset:0 sc1
    ds_read_b64_tr_b16 a[136:137], v10 offset:57344
    v_mfma_f32_16x16x32_bf16 v[100:103], v[180:183], a[36:39], v[100:103]
    v_mfma_f32_16x16x32_bf16 v[32:35], v[184:187], a[36:39], v[32:35]
    ds_read_b64_tr_b16 a[138:139], v10 offset:59392
    v_mfma_f32_16x16x32_bf16 v[36:39], v[188:191], a[36:39], v[36:39]
    s_waitcnt vmcnt(13)
    ds_read_b64_tr_b16 a[140:141], v11 offset:57344
    v_mfma_f32_16x16x32_bf16 v[96:99], v[192:195], a[40:43], v[96:99]
    buffer_load_dwordx4 a[84:87], v2, s[32:35], s14 offen offset:1024 sc1
    ds_read_b64_tr_b16 a[142:143], v11 offset:59392
    v_mfma_f32_16x16x32_bf16 v[100:103], v[196:199], a[40:43], v[100:103]
    v_mfma_f32_16x16x32_bf16 v[32:35], v[200:203], a[40:43], v[32:35]
    ds_read_b64_tr_b16 a[144:145], v8 offset:0
    v_mfma_f32_16x16x32_bf16 v[36:39], v[204:207], a[40:43], v[36:39]
    s_waitcnt vmcnt(13)
    ds_read_b64_tr_b16 a[146:147], v8 offset:2048
    v_mfma_f32_16x16x32_bf16 v[96:99], v[208:211], a[44:47], v[96:99]
    buffer_load_dwordx4 a[88:91], v2, s[32:35], s14 offen offset:2048 sc1
    ds_read_b64_tr_b16 a[148:149], v9 offset:0
    v_mfma_f32_16x16x32_bf16 v[100:103], v[212:215], a[44:47], v[100:103]
    ds_read_b64_tr_b16 a[150:151], v9 offset:2048
    v_mfma_f32_16x16x32_bf16 v[32:35], v[216:219], a[44:47], v[32:35]
    ds_read_b64_tr_b16 a[152:153], v10 offset:0
    v_mfma_f32_16x16x32_bf16 v[36:39], v[220:223], a[44:47], v[36:39]
    s_waitcnt vmcnt(12)
    v_mfma_f32_16x16x32_bf16 v[96:99], v[224:227], a[48:51], v[96:99]
    buffer_load_dwordx4 a[92:95], v2, s[32:35], s14 offen offset:3072 sc1
    ds_read_b64_tr_b16 a[154:155], v10 offset:2048
    v_mfma_f32_16x16x32_bf16 v[100:103], v[228:231], a[48:51], v[100:103]
    ds_read_b64_tr_b16 a[156:157], v11 offset:0
    v_mfma_f32_16x16x32_bf16 v[32:35], v[232:235], a[48:51], v[32:35]
    ds_read_b64_tr_b16 a[158:159], v11 offset:2048
    v_mfma_f32_16x16x32_bf16 v[36:39], v[236:239], a[48:51], v[36:39]
    s_waitcnt vmcnt(12)
    s_add_u32 s14, s14, 4096
    v_mfma_f32_16x16x32_bf16 v[96:99], v[240:243], a[52:55], v[96:99]
    s_waitcnt vmcnt(4)
    s_cmp_eq_u32 s38, 0
    s_cbranch_scc1 sequential_preLN__softmax_full_mha__glu_gated_glu__prompt_kernel_sb16a
    buffer_store_dword v30, v31, s[36:39], s58 offen offset:256
sequential_preLN__softmax_full_mha__glu_gated_glu__prompt_kernel_sb16b:
    buffer_load_dwordx4 a[96:99], v2, s[32:35], s14 offen offset:0 sc1
    v_mfma_f32_16x16x32_bf16 v[100:103], v[244:247], a[52:55], v[100:103]
    ds_read_b64_tr_b16 a[160:161], v8 offset:4096
    ds_read_b64_tr_b16 a[162:163], v8 offset:6144
    v_mfma_f32_16x16x32_bf16 v[32:35], v[248:251], a[52:55], v[32:35]
    ds_read_b64_tr_b16 a[164:165], v9 offset:4096
    v_mfma_f32_16x16x32_bf16 v[36:39], v[252:255], a[52:55], v[36:39]
    s_waitcnt vmcnt(29) lgkmcnt(11)
    ds_read_b64_tr_b16 a[166:167], v9 offset:6144
    v_mfma_f32_16x16x32_bf16 v[64:67], a[128:131], a[0:3], v[64:67]
    buffer_load_dwordx4 a[100:103], v2, s[32:35], s14 offen offset:1024 sc1
    ds_read_b64_tr_b16 a[168:169], v10 offset:4096
    v_mfma_f32_16x16x32_bf16 v[68:71], a[132:135], a[0:3], v[68:71]
    v_mfma_f32_16x16x32_bf16 v[72:75], a[136:139], a[0:3], v[72:75]
    ds_read_b64_tr_b16 a[170:171], v10 offset:6144
    v_mfma_f32_16x16x32_bf16 v[76:79], a[140:143], a[0:3], v[76:79]
    s_waitcnt vmcnt(14)
    ds_read_b64_tr_b16 a[172:173], v11 offset:4096
    v_mfma_f32_16x16x32_bf16 v[96:99], a[128:131], a[56:59], v[96:99]
    buffer_load_dwordx4 a[104:107], v2, s[32:35], s14 offen offset:2048 sc1
    ds_read_b64_tr_b16 a[174:175], v11 offset:6144
    v_mfma_f32_16x16x32_bf16 v[100:103], a[132:135], a[56:59], v[100:103]
    v_mfma_f32_16x16x32_bf16 v[32:35], a[136:139], a[56:59], v[32:35]
    ds_read_b64_tr_b16 a[176:177], v8 offset:8192
    v_mfma_f32_16x16x32_bf16 v[36:39], a[140:143], a[56:59], v[36:39]
    s_waitcnt vmcnt(30) lgkmcnt(9)
    ds_read_b64_tr_b16 a[178:179], v8 offset:10240
    v_mfma_f32_16x16x32_bf16 v[64:67], a[144:147], a[4:7], v[64:67]
    buffer_load_dwordx4 a[108:111], v2, s[32:35], s14 offen offset:3072 sc1
    ds_read_b64_tr_b16 a[180:181], v9 offset:8192
    v_mfma_f32_16x16x32_bf16 v[68:71], a[148:151], a[4:7], v[68:71]
    ds_read_b64_tr_b16 a[182:183], v9 offset:10240
    v_mfma_f32_16x16x32_bf16 v[72:75], a[152:155], a[4:7], v[72:75]
    ds_read_b64_tr_b16 a[184:185], v10 offset:8192
    v_mfma_f32_16x16x32_bf16 v[76:79], a[156:159], a[4:7], v[76:79]
    s_waitcnt vmcnt(15)
    s_add_u32 s14, s14, 4096
    v_mfma_f32_16x16x32_bf16 v[96:99], a[144:147], a[60:63], v[96:99]
    buffer_load_dwordx4 a[112:115], v2, s[32:35], s14 offen offset:0 sc1
    ds_read_b64_tr_b16 a[186:187], v10 offset:10240
    v_mfma_f32_16x16x32_bf16 v[100:103], a[148:151], a[60:63], v[100:103]
    ds_read_b64_tr_b16 a[188:189], v11 offset:8192
    v_mfma_f32_16x16x32_bf16 v[32:35], a[152:155], a[60:63], v[32:35]
    ds_read_b64_tr_b16 a[190:191], v11 offset:10240
    v_mfma_f32_16x16x32_bf16 v[36:39], a[156:159], a[60:63], v[36:39]
    s_waitcnt vmcnt(31) lgkmcnt(8)
    v_mfma_f32_16x16x32_bf16 v[64:67], a[160:163], a[8:11], v[64:67]
    buffer_load_dwordx4 a[116:119], v2, s[32:35], s14 offen offset:1024 sc1
    ds_read_b64_tr_b16 a[192:193], v8 offset:49152
    v_mfma_f32_16x16x32_bf16 v[68:71], a[164:167], a[8:11], v[68:71]
    ds_read_b64_tr_b16 a[194:195], v8 offset:51200
    v_mfma_f32_16x16x32_bf16 v[72:75], a[168:171], a[8:11], v[72:75]
    ds_read_b64_tr_b16 a[196:197], v9 offset:49152
    v_mfma_f32_16x16x32_bf16 v[76:79], a[172:175], a[8:11], v[76:79]
    s_waitcnt vmcnt(15)
    ds_read_b64_tr_b16 a[198:199], v9 offset:51200
    v_mfma_f32_16x16x32_bf16 v[96:99], a[160:163], a[64:67], v[96:99]
    buffer_load_dwordx4 a[120:123], v2, s[32:35], s14 offen offset:2048 sc1
    ds_read_b64_tr_b16 a[200:201], v10 offset:49152
    v_mfma_f32_16x16x32_bf16 v[100:103], a[164:167], a[64:67], v[100:103]
    v_mfma_f32_16x16x32_bf16 v[32:35], a[168:171], a[64:67], v[32:35]
    ds_read_b64_tr_b16 a[202:203], v10 offset:51200
    v_mfma_f32_16x16x32_bf16 v[36:39], a[172:175], a[64:67], v[36:39]
    s_waitcnt vmcnt(32) lgkmcnt(6)
    ds_read_b64_tr_b16 a[204:205], v11 offset:49152
    v_mfma_f32_16x16x32_bf16 v[64:67], a[176:179], a[12:15], v[64:67]
    buffer_load_dwordx4 a[124:127], v2, s[32:35], s14 offen offset:3072 sc1
    ds_read_b64_tr_b16 a[206:207], v11 offset:51200
    v_mfma_f32_16x16x32_bf16 v[68:71], a[180:183], a[12:15], v[68:71]
    v_mfma_f32_16x16x32_bf16 v[72:75], a[184:187], a[12:15], v[72:75]
    ds_read_b64_tr_b16 a[208:209], v8 offset:53248
    v_mfma_f32_16x16x32_bf16 v[76:79], a[188:191], a[12:15], v[76:79]
    s_waitcnt vmcnt(16)
    s_add_u32 s14, s14, 4096
    ds_read_b64_tr_b16 a[210:211], v8 offset:55296
    v_mfma_f32_16x16x32_bf16 v[96:99], a[176:179], a[68:71], v[96:99]
    buffer_load_dwordx4 a[224:227], v2, s[32:35], s14 offen offset:0 sc1
    ds_read_b64_tr_b16 a[212:213], v9 offset:53248
    v_mfma_f32_16x16x32_bf16 v[100:103], a[180:183], a[68:71], v[100:103]
    ds_read_b64_tr_b16 a[214:215], v9 offset:55296
    v_mfma_f32_16x16x32_bf16 v[32:35], a[184:187], a[68:71], v[32:35]
    ds_read_b64_tr_b16 a[216:217], v10 offset:53248
    v_mfma_f32_16x16x32_bf16 v[36:39], a[188:191], a[68:71], v[36:39]
    s_waitcnt vmcnt(33) lgkmcnt(5)
    v_mfma_f32_16x16x32_bf16 v[64:67], a[192:195], a[16:19], v[64:67]
    buffer_load_dwordx4 a[228:231], v2, s[32:35], s14 offen offset:1024 sc1
    ds_read_b64_tr_b16 a[218:219], v10 offset:55296
    v_mfma_f32_16x16x32_bf16 v[68:71], a[196:199], a[16:19], v[68:71]
    ds_read_b64_tr_b16 a[220:221], v11 offset:53248
    v_mfma_f32_16x16x32_bf16 v[72:75], a[200:203], a[16:19], v[72:75]
    buffer_load_dword v23, v21, s[32:35], s16 offen offset:256 sc1
    ds_read_b64_tr_b16 a[222:223], v11 offset:55296
    v_mfma_f32_16x16x32_bf16 v[76:79], a[204:207], a[16:19], v[76:79]
    s_waitcnt vmcnt(18)
    v_mfma_f32_16x16x32_bf16 v[96:99], a[192:195], a[72:75], v[96:99]
    v_mfma_f32_16x16x32_bf16 v[100:103], a[196:199], a[72:75], v[100:103]
    v_mfma_f32_16x16x32_bf16 v[32:35], a[200:203], a[72:75], v[32:35]
    v_mfma_f32_16x16x32_bf16 v[36:39], a[204:207], a[72:75], v[36:39]
    s_waitcnt vmcnt(34) lgkmcnt(0)
    v_mfma_f32_16x16x32_bf16 v[64:67], a[208:211], a[20:23], v[64:67]
    v_mfma_f32_16x16x32_bf16 v[68:71], a[212:215], a[20:23], v[68:71]
    v_mfma_f32_16x16x32_bf16 v[72:75], a[216:219], a[20:23], v[72:75]
    v_mfma_f32_16x16x32_bf16 v[76:79], a[220:223], a[20:23], v[76:79]
    s_waitcnt vmcnt(17)
    v_mfma_f32_16x16x32_bf16 v[96:99], a[208:211], a[76:79], v[96:99]
    v_mfma_f32_16x16x32_bf16 v[100:103], a[212:215], a[76:79], v[100:103]
    v_mfma_f32_16x16x32_bf16 v[32:35], a[216:219], a[76:79], v[32:35]
    v_mfma_f32_16x16x32_bf16 v[36:39], a[220:223], a[76:79], v[36:39]
    s_waitcnt vmcnt(15)
    v_mfma_f32_16x16x32_bf16 v[80:83], v[128:131], a[80:83], 0
    v_mfma_f32_16x16x32_bf16 v[84:87], v[132:135], a[80:83], 0
    ds_write_b128 v24, v[64:67] offset:0
    v_mfma_f32_16x16x32_bf16 v[88:91], v[136:139], a[80:83], 0
    ds_write_b128 v24, v[68:71] offset:1024
    v_mfma_f32_16x16x32_bf16 v[92:95], v[140:143], a[80:83], 0
    s_waitcnt vmcnt(14)
    v_mfma_f32_16x16x32_bf16 v[80:83], v[144:147], a[84:87], v[80:83]
    ds_write_b128 v25, v[72:75] offset:0
    v_mfma_f32_16x16x32_bf16 v[84:87], v[148:151], a[84:87], v[84:87]
    s_waitcnt vmcnt(0)
    v_cmp_ne_u32 vcc, s44, v23
    v_mfma_f32_16x16x32_bf16 v[88:91], v[152:155], a[84:87], v[88:91]
    s_cbranch_vccnz sequential_preLN__softmax_full_mha__glu_gated_glu__prompt_kernel_f2r
sequential_preLN__softmax_full_mha__glu_gated_glu__prompt_kernel_f2d:
    ds_write_b128 v25, v[76:79] offset:1024
    v_mfma_f32_16x16x32_bf16 v[92:95], v[156:159], a[84:87], v[92:95]
    s_waitcnt vmcnt(13)
    v_mfma_f32_16x16x32_bf16 v[80:83], v[160:163], a[88:91], v[80:83]
    buffer_load_dwordx4 a[232:235], v2, s[32:35], s15 offen offset:0 sc1
    ds_write_b128 v26, v[96:99] offset:0
    v_mfma_f32_16x16x32_bf16 v[84:87], v[164:167], a[88:91], v[84:87]
    v_mfma_f32_16x16x32_bf16 v[88:91], v[168:171], a[88:91], v[88:91]
    ds_write_b128 v26, v[100:103] offset:1024
    v_mfma_f32_16x16x32_bf16 v[92:95], v[172:175], a[88:91], v[92:95]
    s_waitcnt vmcnt(13)
    buffer_load_dwordx4 a[236:239], v2, s[32:35], s15 offen offset:1024 sc1
    v_mfma_f32_16x16x32_bf16 v[80:83], v[176:179], a[92:95], v[80:83]
    v_mfma_f32_16x16x32_bf16 v[84:87], v[180:183], a[92:95], v[84:87]
    v_mfma_f32_16x16x32_bf16 v[88:91], v[184:187], a[92:95], v[88:91]
    v_mfma_f32_16x16x32_bf16 v[92:95], v[188:191], a[92:95], v[92:95]
    s_waitcnt vmcnt(12)
    buffer_load_dwordx4 a[240:243], v2, s[32:35], s15 offen offset:2048 sc1
    v_mfma_f32_16x16x32_bf16 v[80:83], v[192:195], a[96:99], v[80:83]
    v_mfma_f32_16x16x32_bf16 v[84:87], v[196:199], a[96:99], v[84:87]
    v_mfma_f32_16x16x32_bf16 v[88:91], v[200:203], a[96:99], v[88:91]
    buffer_load_dwordx4 a[244:247], v2, s[32:35], s15 offen offset:3072 sc1
    v_mfma_f32_16x16x32_bf16 v[92:95], v[204:207], a[96:99], v[92:95]
    s_waitcnt vmcnt(13)
    v_mfma_f32_16x16x32_bf16 v[80:83], v[208:211], a[100:103], v[80:83]
    s_waitcnt lgkmcnt(0)
    s_barrier
    v_mfma_f32_16x16x32_bf16 v[84:87], v[212:215], a[100:103], v[84:87]
    s_add_u32 s15, s15, 4096
    ds_read_b128 v[48:51], v27 offset:0
    ds_read_b128 v[52:55], v27 offset:1024
    v_mfma_f32_16x16x32_bf16 v[88:91], v[216:219], a[100:103], v[88:91]
    buffer_load_dwordx4 a[248:251], v2, s[32:35], s15 offen offset:0 sc1
    ds_read_b128 v[56:59], v27 offset:2048
    v_mfma_f32_16x16x32_bf16 v[92:95], v[220:223], a[100:103], v[92:95]
    s_waitcnt vmcnt(13)
    ds_read_b128 v[60:63], v27 offset:3072
    v_mfma_f32_16x16x32_bf16 v[80:83], v[224:227], a[104:107], v[80:83]
    ds_read_b128 v[64:67], v27 offset:4096
    v_mfma_f32_16x16x32_bf16 v[84:87], v[228:231], a[104:107], v[84:87]
sequential_preLN__softmax_full_mha__glu_gated_glu__prompt_kernel_pg8:
    s_cbranch_execz sequential_preLN__softmax_full_mha__glu_gated_glu__prompt_kernel_tb5
    buffer_load_dwordx4 a[252:255], v2, s[32:35], s15 offen offset:1024 sc1
    ds_read_b128 v[68:71], v27 offset:5120
    v_mfma_f32_16x16x32_bf16 v[88:91], v[232:235], a[104:107], v[88:91]
    v_mfma_f32_16x16x32_bf16 v[92:95], v[236:239], a[104:107], v[92:95]
    s_waitcnt vmcnt(13)
    s_waitcnt lgkmcnt(2)
    v_add_f32 v48, v48, v56
    v_mfma_f32_16x16x32_bf16 v[80:83], v[240:243], a[108:111], v[80:83]
    v_add_f32 v49, v49, v57
    v_add_f32 v50, v50, v58
    v_mfma_f32_16x16x32_bf16 v[84:87], v[244:247], a[108:111], v[84:87]
    buffer_load_dwordx4 a[0:3], v2, s[32:35], s15 offen offset:2048 sc1
    v_add_f32 v51, v51, v59
    v_mfma_f32_16x16x32_bf16 v[88:91], v[248:251], a[108:111], v[88:91]
    v_add_f32 v52, v52, v60
    v_mfma_f32_16x16x32_bf16 v[92:95], v[252:255], a[108:111], v[92:95]
    s_waitcnt vmcnt(13)
    v_add_f32 v53, v53, v61
    v_mfma_f32_16x16x32_bf16 v[80:83], a[128:131], a[112:115], v[80:83]
    buffer_load_dwordx4 a[4:7], v2, s[32:35], s15 offen offset:3072 sc1
    v_add_f32 v54, v54, v62
    v_mfma_f32_16x16x32_bf16 v[84:87], a[132:135], a[112:115], v[84:87]
    v_add_f32 v55, v55, v63
    v_mfma_f32_16x16x32_bf16 v[88:91], a[136:139], a[112:115], v[88:91]
    s_waitcnt lgkmcnt(0)
    v_add_f32 v48, v48, v64
    v_mfma_f32_16x16x32_bf16 v[92:95], a[140:143], a[112:115], v[92:95]
    s_waitcnt vmcnt(13)
    s_add_u32 s15, s15, 4096
    v_add_f32 v49, v49, v65
    v_mfma_f32_16x16x32_bf16 v[80:83], a[144:147], a[116:119], v[80:83]
    buffer_load_dwordx4 a[8:11], v2, s[32:35], s15 offen offset:0 sc1
    v_add_f32 v50, v50, v66
    v_mfma_f32_16x16x32_bf16 v[84:87], a[148:151], a[116:119], v[84:87]
    v_add_f32 v51, v51, v67
    v_mfma_f32_16x16x32_bf16 v[88:91], a[152:155], a[116:119], v[88:91]
    v_add_f32 v52, v52, v68
    v_mfma_f32_16x16x32_bf16 v[92:95], a[156:159], a[116:119], v[92:95]
    s_waitcnt vmcnt(13)
    buffer_load_dwordx4 a[12:15], v2, s[32:35], s15 offen offset:1024 sc1
    v_add_f32 v53, v53, v69
    v_mfma_f32_16x16x32_bf16 v[80:83], a[160:163], a[120:123], v[80:83]
    v_add_f32 v54, v54, v70
    v_mfma_f32_16x16x32_bf16 v[84:87], a[164:167], a[120:123], v[84:87]
    v_add_f32 v55, v55, v71
    v_mfma_f32_16x16x32_bf16 v[88:91], a[168:171], a[120:123], v[88:91]
    v_add_f32 v32, v32, v48
    v_mfma_f32_16x16x32_bf16 v[92:95], a[172:175], a[120:123], v[92:95]
    s_waitcnt vmcnt(13)
    buffer_load_dwordx4 a[16:19], v2, s[32:35], s15 offen offset:2048 sc1
    v_add_f32 v33, v33, v49
    v_mfma_f32_16x16x32_bf16 v[80:83], a[176:179], a[124:127], v[80:83]
    v_add_f32 v34, v34, v50
    v_mfma_f32_16x16x32_bf16 v[84:87], a[180:183], a[124:127], v[84:87]
    v_add_f32 v35, v35, v51
    v_mfma_f32_16x16x32_bf16 v[88:91], a[184:187], a[124:127], v[88:91]
    buffer_load_dwordx4 a[20:23], v2, s[32:35], s15 offen offset:3072 sc1
    v_add_f32 v36, v36, v52
    v_mfma_f32_16x16x32_bf16 v[92:95], a[188:191], a[124:127], v[92:95]
    s_waitcnt vmcnt(14)
    v_add_f32 v37, v37, v53
    v_mfma_f32_16x16x32_bf16 v[80:83], a[192:195], a[224:227], v[80:83]
    v_add_f32 v38, v38, v54
    v_mfma_f32_16x16x32_bf16 v[84:87], a[196:199], a[224:227], v[84:87]
    s_add_u32 s15, s15, 4096
    v_add_f32 v39, v39, v55
    v_mfma_f32_16x16x32_bf16 v[88:91], a[200:203], a[224:227], v[88:91]
    buffer_load_dwordx4 a[24:27], v2, s[32:35], s15 offen offset:0 sc1
    v_cvt_pk_bf16_f32 v112, v32, v33
    v_mfma_f32_16x16x32_bf16 v[92:95], a[204:207], a[224:227], v[92:95]
    s_waitcnt vmcnt(14)
    v_cvt_pk_bf16_f32 v114, v36, v37
    v_mfma_f32_16x16x32_bf16 v[80:83], a[208:211], a[228:231], v[80:83]
    v_cvt_pk_bf16_f32 v113, v34, v35
    v_mfma_f32_16x16x32_bf16 v[84:87], a[212:215], a[228:231], v[84:87]
    buffer_load_dwordx4 a[28:31], v2, s[32:35], s15 offen offset:1024 sc1
    v_cvt_pk_bf16_f32 v115, v38, v39
    v_mfma_f32_16x16x32_bf16 v[88:91], a[216:219], a[228:231], v[88:91]
    s_add_u32 s4, s55, 0
    v_permlane16_swap_b32 v112, v114
    v_mfma_f32_16x16x32_bf16 v[92:95], a[220:223], a[228:231], v[92:95]
    s_waitcnt vmcnt(13)
    v_permlane16_swap_b32 v113, v115
    v_mfma_f32_16x16x32_bf16 v[104:107], v[128:131], a[232:235], 0
    v_mfma_f32_16x16x32_bf16 v[108:111], v[132:135], a[232:235], 0
    s_waitcnt vmcnt(12)
    v_mfma_f32_16x16x32_bf16 v[104:107], v[144:147], a[236:239], v[104:107]
    buffer_store_dwordx4 v[112:115], v28, s[28:31], s4 offen sc1
    v_mfma_f32_16x16x32_bf16 v[108:111], v[148:151], a[236:239], v[108:111]
    s_waitcnt vmcnt(12)
    v_mfma_f32_16x16x32_bf16 v[104:107], v[160:163], a[240:243], v[104:107]
    ds_write_b128 v24, v[80:83] offset:28672
    v_mfma_f32_16x16x32_bf16 v[108:111], v[164:167], a[240:243], v[108:111]
    s_waitcnt vmcnt(11)
    v_mfma_f32_16x16x32_bf16 v[104:107], v[176:179], a[244:247], v[104:107]
    v_mfma_f32_16x16x32_bf16 v[108:111], v[180:183], a[244:247], v[108:111]
    s_waitcnt vmcnt(10)
    ds_write_b128 v24, v[84:87] offset:29696
    v_mfma_f32_16x16x32_bf16 v[104:107], v[192:195], a[248:251], v[104:107]
    v_mfma_f32_16x16x32_bf16 v[108:111], v[196:199], a[248:251], v[108:111]
    s_waitcnt vmcnt(9)
    v_mfma_f32_16x16x32_bf16 v[104:107], v[208:211], a[252:255], v[104:107]
    ds_write_b128 v25, v[88:91] offset:28672
    v_mfma_f32_16x16x32_bf16 v[108:111], v[212:215], a[252:255], v[108:111]
    s_waitcnt vmcnt(8)
    v_mfma_f32_16x16x32_bf16 v[104:107], v[224:227], a[0:3], v[104:107]
    v_mfma_f32_16x16x32_bf16 v[108:111], v[228:231], a[0:3], v[108:111]
    s_waitcnt vmcnt(7)
    ds_write_b128 v25, v[92:95] offset:29696
    v_mfma_f32_16x16x32_bf16 v[104:107], v[240:243], a[4:7], v[104:107]
    v_mfma_f32_16x16x32_bf16 v[108:111], v[244:247], a[4:7], v[108:111]
    s_waitcnt vmcnt(6)
    v_mfma_f32_16x16x32_bf16 v[104:107], a[128:131], a[8:11], v[104:107]
    v_mfma_f32_16x16x32_bf16 v[108:111], a[132:135], a[8:11], v[108:111]
    s_waitcnt vmcnt(5)
    v_mfma_f32_16x16x32_bf16 v[104:107], a[144:147], a[12:15], v[104:107]
    v_mfma_f32_16x16x32_bf16 v[108:111], a[148:151], a[12:15], v[108:111]
    s_waitcnt vmcnt(4)
    v_mfma_f32_16x16x32_bf16 v[104:107], a[160:163], a[16:19], v[104:107]
    v_mfma_f32_16x16x32_bf16 v[108:111], a[164:167], a[16:19], v[108:111]
    s_waitcnt vmcnt(3)
    v_mfma_f32_16x16x32_bf16 v[104:107], a[176:179], a[20:23], v[104:107]
    v_mfma_f32_16x16x32_bf16 v[108:111], a[180:183], a[20:23], v[108:111]
    s_waitcnt vmcnt(2)
    v_mfma_f32_16x16x32_bf16 v[104:107], a[192:195], a[24:27], v[104:107]
    v_mfma_f32_16x16x32_bf16 v[108:111], a[196:199], a[24:27], v[108:111]
    s_waitcnt vmcnt(1)
    v_mfma_f32_16x16x32_bf16 v[104:107], a[208:211], a[28:31], v[104:107]
    v_mfma_f32_16x16x32_bf16 v[108:111], a[212:215], a[28:31], v[108:111]
    v_mfma_f32_16x16x32_bf16 v[40:43], v[136:139], a[232:235], v[40:43]
    v_mfma_f32_16x16x32_bf16 v[44:47], v[140:143], a[232:235], v[44:47]
    v_mfma_f32_16x16x32_bf16 v[40:43], v[152:155], a[236:239], v[40:43]
    v_mfma_f32_16x16x32_bf16 v[44:47], v[156:159], a[236:239], v[44:47]
    s_nop 2
    ds_write_b128 v26, v[104:107] offset:28672
    ds_write_b128 v26, v[108:111] offset:29696
    v_mfma_f32_16x16x32_bf16 v[40:43], v[168:171], a[240:243], v[40:43]
    v_mfma_f32_16x16x32_bf16 v[44:47], v[172:175], a[240:243], v[44:47]
    v_mfma_f32_16x16x32_bf16 v[40:43], v[184:187], a[244:247], v[40:43]
    v_mfma_f32_16x16x32_bf16 v[44:47], v[188:191], a[244:247], v[44:47]
    v_mfma_f32_16x16x32_bf16 v[40:43], v[200:203], a[248:251], v[40:43]
    v_mfma_f32_16x16x32_bf16 v[44:47], v[204:207], a[248:251], v[44:47]
    v_mfma_f32_16x16x32_bf16 v[40:43], v[216:219], a[252:255], v[40:43]
    s_waitcnt lgkmcnt(0)
    s_barrier
    v_mfma_f32_16x16x32_bf16 v[44:47], v[220:223], a[252:255], v[44:47]
    ds_read_b128 v[48:51], v27 offset:28672
    ds_read_b128 v[52:55], v27 offset:29696
    v_mfma_f32_16x16x32_bf16 v[40:43], v[232:235], a[0:3], v[40:43]
    ds_read_b128 v[56:59], v27 offset:30720
    v_mfma_f32_16x16x32_bf16 v[44:47], v[236:239], a[0:3], v[44:47]
    ds_read_b128 v[60:63], v27 offset:31744
    v_mfma_f32_16x16x32_bf16 v[40:43], v[248:251], a[4:7], v[40:43]
    ds_read_b128 v[64:67], v27 offset:32768
    ds_read_b128 v[68:71], v27 offset:33792
    v_mfma_f32_16x16x32_bf16 v[44:47], v[252:255], a[4:7], v[44:47]
    v_mfma_f32_16x16x32_bf16 v[40:43], a[136:139], a[8:11], v[40:43]
    s_waitcnt lgkmcnt(2)
    v_add_f32 v48, v48, v56
    v_add_f32 v49, v49, v57
    v_mfma_f32_16x16x32_bf16 v[44:47], a[140:143], a[8:11], v[44:47]
    v_add_f32 v50, v50, v58
    v_add_f32 v51, v51, v59
    v_mfma_f32_16x16x32_bf16 v[40:43], a[152:155], a[12:15], v[40:43]
    v_add_f32 v52, v52, v60
    v_mfma_f32_16x16x32_bf16 v[44:47], a[156:159], a[12:15], v[44:47]
    v_add_f32 v53, v53, v61
    v_mfma_f32_16x16x32_bf16 v[40:43], a[168:171], a[16:19], v[40:43]
    v_add_f32 v54, v54, v62
    v_mfma_f32_16x16x32_bf16 v[44:47], a[172:175], a[16:19], v[44:47]
    v_add_f32 v55, v55, v63
    s_waitcnt lgkmcnt(0)
    v_mfma_f32_16x16x32_bf16 v[40:43], a[184:187], a[20:23], v[40:43]
    v_add_f32 v48, v48, v64
    v_add_f32 v49, v49, v65
    v_mfma_f32_16x16x32_bf16 v[44:47], a[188:191], a[20:23], v[44:47]
    v_add_f32 v50, v50, v66
    v_mfma_f32_16x16x32_bf16 v[40:43], a[200:203], a[24:27], v[40:43]
    v_add_f32 v51, v51, v67
    v_add_f32 v52, v52, v68
    v_mfma_f32_16x16x32_bf16 v[44:47], a[204:207], a[24:27], v[44:47]
    v_add_f32 v53, v53, v69
    v_mfma_f32_16x16x32_bf16 v[40:43], a[216:219], a[28:31], v[40:43]
    v_add_f32 v54, v54, v70
    v_mfma_f32_16x16x32_bf16 v[44:47], a[220:223], a[28:31], v[44:47]
    v_add_f32 v55, v55, v71
    s_nop 4
    v_pk_add_f32 v[40:41], v[40:41], v[48:49]
    v_pk_add_f32 v[42:43], v[42:43], v[50:51]
    v_pk_add_f32 v[44:45], v[44:45], v[52:53]
    v_pk_add_f32 v[46:47], v[46:47], v[54:55]
    v_cvt_pk_bf16_f32 v112, v40, v41
    v_cvt_pk_bf16_f32 v114, v44, v45
    v_cvt_pk_bf16_f32 v113, v42, v43
    v_cvt_pk_bf16_f32 v115, v46, v47
    s_add_u32 s4, s55, 57344
    v_permlane16_swap_b32 v112, v114
    v_permlane16_swap_b32 v113, v115
    buffer_store_dwordx4 v[112:115], v28, s[28:31], s4 offen
sequential_preLN__softmax_full_mha__glu_gated_glu__prompt_kernel_fin:
    s_or_b32 s4, s2, s3
    s_cmp_lg_u32 s4, 0
    s_cbranch_scc1 sequential_preLN__softmax_full_mha__glu_gated_glu__prompt_kernel_fin2
    s_mov_b32 s4, 18874380
    buffer_store_dword v30, v31, s[32:35], s4 offen
sequential_preLN__softmax_full_mha__glu_gated_glu__prompt_kernel_fin2:
sequential_preLN__softmax_full_mha__glu_gated_glu__prompt_kernel_exit:
    s_endpgm
sequential_preLN__softmax_full_mha__glu_gated_glu__prompt_kernel_sb1a:
    buffer_store_dwordx4 v[176:179], v2, s[40:43], s55 offen offset:0 sc1
    s_branch sequential_preLN__softmax_full_mha__glu_gated_glu__prompt_kernel_sb1b
sequential_preLN__softmax_full_mha__glu_gated_glu__prompt_kernel_sb2a:
    buffer_store_dwordx4 v[180:183], v2, s[40:43], s55 offen offset:1024 sc1
    s_branch sequential_preLN__softmax_full_mha__glu_gated_glu__prompt_kernel_sb2b
sequential_preLN__softmax_full_mha__glu_gated_glu__prompt_kernel_sb3a:
    buffer_store_dwordx4 v[184:187], v2, s[40:43], s4 offen offset:0 sc1
    s_branch sequential_preLN__softmax_full_mha__glu_gated_glu__prompt_kernel_sb3b
sequential_preLN__softmax_full_mha__glu_gated_glu__prompt_kernel_sb4a:
    buffer_store_dwordx4 v[188:191], v2, s[40:43], s4 offen offset:1024 sc1
    s_branch sequential_preLN__softmax_full_mha__glu_gated_glu__prompt_kernel_sb4b
sequential_preLN__softmax_full_mha__glu_gated_glu__prompt_kernel_sb5a:
    buffer_store_dword v30, v31, s[40:43], s4 offen offset:0 sc1
    s_branch sequential_preLN__softmax_full_mha__glu_gated_glu__prompt_kernel_sb5b
sequential_preLN__softmax_full_mha__glu_gated_glu__prompt_kernel_fb:
    v_mov_b32 v6, 0xff800000
    s_mov_b32 s4, s56
    s_mov_b32 s5, 64
sequential_preLN__softmax_full_mha__glu_gated_glu__prompt_kernel_fb1:
    buffer_load_dwordx4 v[144:147], v2, s[32:35], s4 offen offset:0 sc1
    buffer_load_dwordx4 v[148:151], v2, s[32:35], s4 offen offset:1024 sc1
    s_add_u32 s4, s4, 4096
    s_sub_u32 s5, s5, 1
    s_waitcnt vmcnt(0)
    v_mfma_f32_32x32x16_bf16 v[32:47], v[144:147], a[248:251], 0
    v_mfma_f32_32x32x16_bf16 v[32:47], v[148:151], a[252:255], v[32:47]
    s_nop 11
    v_max3_f32 v6, v6, v32, v33
    v_max3_f32 v6, v6, v34, v35
    v_max3_f32 v6, v6, v36, v37
    v_max3_f32 v6, v6, v38, v39
    v_max3_f32 v6, v6, v40, v41
    v_max3_f32 v6, v6, v42, v43
    v_max3_f32 v6, v6, v44, v45
    v_max3_f32 v6, v6, v46, v47
    s_cmp_lg_u32 s5, 0
    s_cbranch_scc1 sequential_preLN__softmax_full_mha__glu_gated_glu__prompt_kernel_fb1
    v_mov_b32 v7, v6
    s_nop 1
    v_permlane32_swap_b32 v6, v7
    v_max_f32 v6, v6, v7
    v_mov_b32 v128, 0
    v_mov_b32 v129, 0
    v_mov_b32 v130, 0
    v_mov_b32 v131, 0
    v_mov_b32 v132, 0
    v_mov_b32 v133, 0
    v_mov_b32 v134, 0
    v_mov_b32 v135, 0
    v_mov_b32 v136, 0
    v_mov_b32 v137, 0
    v_mov_b32 v138, 0
    v_mov_b32 v139, 0
    v_mov_b32 v140, 0
    v_mov_b32 v141, 0
    v_mov_b32 v142, 0
    v_mov_b32 v143, 0
    s_mov_b32 s4, s56
    s_mov_b32 s5, 64
sequential_preLN__softmax_full_mha__glu_gated_glu__prompt_kernel_fb2:
    buffer_load_dwordx4 v[144:147], v2, s[32:35], s4 offen offset:0 sc1
    buffer_load_dwordx4 v[148:151], v2, s[32:35], s4 offen offset:1024 sc1
    buffer_load_dwordx4 v[152:155], v2, s[32:35], s4 offen offset:2048 sc1
    buffer_load_dwordx4 v[156:159], v2, s[32:35], s4 offen offset:3072 sc1
    s_add_u32 s4, s4, 4096
    s_sub_u32 s5, s5, 1
    s_waitcnt vmcnt(0)
    v_mfma_f32_32x32x16_bf16 v[32:47], v[144:147], a[248:251], 0
    v_mfma_f32_32x32x16_bf16 v[32:47], v[148:151], a[252:255], v[32:47]
    s_nop 11
    v_sub_f32 v32, v32, v6
    v_sub_f32 v33, v33, v6
    v_sub_f32 v34, v34, v6
    v_sub_f32 v35, v35, v6
    v_sub_f32 v36, v36, v6
    v_sub_f32 v37, v37, v6
    v_sub_f32 v38, v38, v6
    v_sub_f32 v39, v39, v6
    v_sub_f32 v40, v40, v6
    v_sub_f32 v41, v41, v6
    v_sub_f32 v42, v42, v6
    v_sub_f32 v43, v43, v6
    v_sub_f32 v44, v44, v6
    v_sub_f32 v45, v45, v6
    v_sub_f32 v46, v46, v6
    v_sub_f32 v47, v47, v6
    v_exp_f32 v32, v32
    v_exp_f32 v33, v33
    v_exp_f32 v34, v34
    v_exp_f32 v35, v35
    v_exp_f32 v36, v36
    v_exp_f32 v37, v37
    v_exp_f32 v38, v38
    v_exp_f32 v39, v39
    v_exp_f32 v40, v40
    v_exp_f32 v41, v41
    v_exp_f32 v42, v42
    v_exp_f32 v43, v43
    v_exp_f32 v44, v44
    v_exp_f32 v45, v45
    v_exp_f32 v46, v46
    v_exp_f32 v47, v47
    v_smfmac_f32_32x32x32_bf16 v[128:143], v[152:155], v[32:39], v3
    s_nop 0
    v_smfmac_f32_32x32x32_bf16 v[128:143], v[156:159], v[40:47], v3
    s_nop 7
    s_cmp_lg_u32 s5, 0
    s_cbranch_scc1 sequential_preLN__softmax_full_mha__glu_gated_glu__prompt_kernel_fb2
    s_branch sequential_preLN__softmax_full_mha__glu_gated_glu__prompt_kernel_norm
sequential_preLN__softmax_full_mha__glu_gated_glu__prompt_kernel_spare:
    s_barrier
    buffer_store_dword v30, v31, s[36:39], s60 offen offset:0
    buffer_store_dword v30, v31, s[40:43], s60 offen offset:0 sc1
    s_cmp_eq_u32 s38, 0
    s_cbranch_scc1 sequential_preLN__softmax_full_mha__glu_gated_glu__prompt_kernel_spare2
    s_sub_u32 s4, s7, 28
    s_lshl_b32 s4, s4, 2
    s_add_u32 s4, s4, s3
    s_lshl_b32 s4, s4, 13
    s_add_u32 s4, s4, s45
    v_lshlrev_b32 v6, 7, v1
    s_add_u32 s5, s4, 0
    buffer_load_dword v5, v6, s[32:35], s5 offen sc1
    s_add_u32 s5, s4, 131072
    buffer_load_dword v5, v6, s[32:35], s5 offen sc1
sequential_preLN__softmax_full_mha__glu_gated_glu__prompt_kernel_spare2:
    s_waitcnt vmcnt(0) lgkmcnt(0)
    s_branch sequential_preLN__softmax_full_mha__glu_gated_glu__prompt_kernel_fin
sequential_preLN__softmax_full_mha__glu_gated_glu__prompt_kernel_sb6a:
    buffer_store_dword v30, v31, s[40:43], s60 offen offset:0 sc1
    s_branch sequential_preLN__softmax_full_mha__glu_gated_glu__prompt_kernel_sb6b
sequential_preLN__softmax_full_mha__glu_gated_glu__prompt_kernel_or0:
    s_mov_b32 s63, 65536
sequential_preLN__softmax_full_mha__glu_gated_glu__prompt_kernel_os0:
    buffer_load_dwordx4 v[64:67], v2, s[32:35], s12 offen offset:0 sc1
    buffer_load_dwordx4 v[68:71], v0, s[32:35], s12 offen offset:0 sc1
    buffer_load_dwordx4 v[72:75], v2, s[32:35], s12 offen offset:1024 sc1
    buffer_load_dwordx4 v[76:79], v0, s[32:35], s12 offen offset:1024 sc1
    s_waitcnt vmcnt(4)
    v_xor_b32 v4, s61, v83
    v_xor_b32 v5, s61, v87
    v_or_b32 v4, v4, v5
    v_xor_b32 v5, s61, v91
    v_or_b32 v4, v4, v5
    v_xor_b32 v5, s61, v95
    v_or_b32 v4, v4, v5
    v_cmp_lt_u32 vcc, s5, v4
    s_cbranch_vccz sequential_preLN__softmax_full_mha__glu_gated_glu__prompt_kernel_ot01
    buffer_load_dwordx4 v[80:83], v2, s[32:35], s13 offen offset:0 sc1
    buffer_load_dwordx4 v[84:87], v0, s[32:35], s13 offen offset:0 sc1
    buffer_load_dwordx4 v[88:91], v2, s[32:35], s13 offen offset:1024 sc1
    buffer_load_dwordx4 v[92:95], v0, s[32:35], s13 offen offset:1024 sc1
sequential_preLN__softmax_full_mha__glu_gated_glu__prompt_kernel_ot01:
    v_xor_b32 v4, s61, v99
    v_xor_b32 v5, s61, v103
    v_or_b32 v4, v4, v5
    v_xor_b32 v5, s61, v107
    v_or_b32 v4, v4, v5
    v_xor_b32 v5, s61, v111
    v_or_b32 v4, v4, v5
    v_cmp_lt_u32 vcc, s5, v4
    s_cbranch_vccz sequential_preLN__softmax_full_mha__glu_gated_glu__prompt_kernel_ot02
    buffer_load_dwordx4 v[96:99], v2, s[32:35], s14 offen offset:0 sc1
    buffer_load_dwordx4 v[100:103], v0, s[32:35], s14 offen offset:0 sc1
    buffer_load_dwordx4 v[104:107], v2, s[32:35], s14 offen offset:1024 sc1
    buffer_load_dwordx4 v[108:111], v0, s[32:35], s14 offen offset:1024 sc1
sequential_preLN__softmax_full_mha__glu_gated_glu__prompt_kernel_ot02:
    v_xor_b32 v4, s61, v115
    v_xor_b32 v5, s61, v119
    v_or_b32 v4, v4, v5
    v_xor_b32 v5, s61, v123
    v_or_b32 v4, v4, v5
    v_xor_b32 v5, s61, v127
    v_or_b32 v4, v4, v5
    v_cmp_lt_u32 vcc, s5, v4
    s_cbranch_vccz sequential_preLN__softmax_full_mha__glu_gated_glu__prompt_kernel_ot03
    buffer_load_dwordx4 v[112:115], v2, s[32:35], s15 offen offset:0 sc1
    buffer_load_dwordx4 v[116:119], v0, s[32:35], s15 offen offset:0 sc1
    buffer_load_dwordx4 v[120:123], v2, s[32:35], s15 offen offset:1024 sc1
    buffer_load_dwordx4 v[124:127], v0, s[32:35], s15 offen offset:1024 sc1
sequential_preLN__softmax_full_mha__glu_gated_glu__prompt_kernel_ot03:
    s_sub_u32 s63, s63, 1
    s_waitcnt vmcnt(0)
    s_cbranch_scc1 sequential_preLN__softmax_full_mha__glu_gated_glu__prompt_kernel_od0
    v_xor_b32 v67, s61, v67
    v_xor_b32 v71, s61, v71
    v_xor_b32 v75, s61, v75
    v_xor_b32 v79, s61, v79
    v_or3_b32 v4, v67, v71, v75
    v_or_b32 v4, v4, v79
    v_cmp_lt_u32 vcc, s5, v4
    s_cbranch_vccnz sequential_preLN__softmax_full_mha__glu_gated_glu__prompt_kernel_os0
    s_branch sequential_preLN__softmax_full_mha__glu_gated_glu__prompt_kernel_od0
sequential_preLN__softmax_full_mha__glu_gated_glu__prompt_kernel_or1:
    s_mov_b32 s63, 65536
sequential_preLN__softmax_full_mha__glu_gated_glu__prompt_kernel_os1:
    buffer_load_dwordx4 v[80:83], v2, s[32:35], s13 offen offset:0 sc1
    buffer_load_dwordx4 v[84:87], v0, s[32:35], s13 offen offset:0 sc1
    buffer_load_dwordx4 v[88:91], v2, s[32:35], s13 offen offset:1024 sc1
    buffer_load_dwordx4 v[92:95], v0, s[32:35], s13 offen offset:1024 sc1
    s_waitcnt vmcnt(4)
    v_xor_b32 v4, s61, v99
    v_xor_b32 v5, s61, v103
    v_or_b32 v4, v4, v5
    v_xor_b32 v5, s61, v107
    v_or_b32 v4, v4, v5
    v_xor_b32 v5, s61, v111
    v_or_b32 v4, v4, v5
    v_cmp_lt_u32 vcc, s5, v4
    s_cbranch_vccz sequential_preLN__softmax_full_mha__glu_gated_glu__prompt_kernel_ot12
    buffer_load_dwordx4 v[96:99], v2, s[32:35], s14 offen offset:0 sc1
    buffer_load_dwordx4 v[100:103], v0, s[32:35], s14 offen offset:0 sc1
    buffer_load_dwordx4 v[104:107], v2, s[32:35], s14 offen offset:1024 sc1
    buffer_load_dwordx4 v[108:111], v0, s[32:35], s14 offen offset:1024 sc1
sequential_preLN__softmax_full_mha__glu_gated_glu__prompt_kernel_ot12:
    v_xor_b32 v4, s61, v115
    v_xor_b32 v5, s61, v119
    v_or_b32 v4, v4, v5
    v_xor_b32 v5, s61, v123
    v_or_b32 v4, v4, v5
    v_xor_b32 v5, s61, v127
    v_or_b32 v4, v4, v5
    v_cmp_lt_u32 vcc, s5, v4
    s_cbranch_vccz sequential_preLN__softmax_full_mha__glu_gated_glu__prompt_kernel_ot13
    buffer_load_dwordx4 v[112:115], v2, s[32:35], s15 offen offset:0 sc1
    buffer_load_dwordx4 v[116:119], v0, s[32:35], s15 offen offset:0 sc1
    buffer_load_dwordx4 v[120:123], v2, s[32:35], s15 offen offset:1024 sc1
    buffer_load_dwordx4 v[124:127], v0, s[32:35], s15 offen offset:1024 sc1
sequential_preLN__softmax_full_mha__glu_gated_glu__prompt_kernel_ot13:
    s_sub_u32 s63, s63, 1
    s_waitcnt vmcnt(0)
    s_cbranch_scc1 sequential_preLN__softmax_full_mha__glu_gated_glu__prompt_kernel_od1
    v_xor_b32 v83, s61, v83
    v_xor_b32 v87, s61, v87
    v_xor_b32 v91, s61, v91
    v_xor_b32 v95, s61, v95
    v_or3_b32 v4, v83, v87, v91
    v_or_b32 v4, v4, v95
    v_cmp_lt_u32 vcc, s5, v4
    s_cbranch_vccnz sequential_preLN__softmax_full_mha__glu_gated_glu__prompt_kernel_os1
    s_branch sequential_preLN__softmax_full_mha__glu_gated_glu__prompt_kernel_od1
sequential_preLN__softmax_full_mha__glu_gated_glu__prompt_kernel_or2:
    s_mov_b32 s63, 65536
sequential_preLN__softmax_full_mha__glu_gated_glu__prompt_kernel_os2:
    buffer_load_dwordx4 v[96:99], v2, s[32:35], s14 offen offset:0 sc1
    buffer_load_dwordx4 v[100:103], v0, s[32:35], s14 offen offset:0 sc1
    buffer_load_dwordx4 v[104:107], v2, s[32:35], s14 offen offset:1024 sc1
    buffer_load_dwordx4 v[108:111], v0, s[32:35], s14 offen offset:1024 sc1
    s_waitcnt vmcnt(4)
    v_xor_b32 v4, s61, v115
    v_xor_b32 v5, s61, v119
    v_or_b32 v4, v4, v5
    v_xor_b32 v5, s61, v123
    v_or_b32 v4, v4, v5
    v_xor_b32 v5, s61, v127
    v_or_b32 v4, v4, v5
    v_cmp_lt_u32 vcc, s5, v4
    s_cbranch_vccz sequential_preLN__softmax_full_mha__glu_gated_glu__prompt_kernel_ot23
    buffer_load_dwordx4 v[112:115], v2, s[32:35], s15 offen offset:0 sc1
    buffer_load_dwordx4 v[116:119], v0, s[32:35], s15 offen offset:0 sc1
    buffer_load_dwordx4 v[120:123], v2, s[32:35], s15 offen offset:1024 sc1
    buffer_load_dwordx4 v[124:127], v0, s[32:35], s15 offen offset:1024 sc1
sequential_preLN__softmax_full_mha__glu_gated_glu__prompt_kernel_ot23:
    s_sub_u32 s63, s63, 1
    s_waitcnt vmcnt(0)
    s_cbranch_scc1 sequential_preLN__softmax_full_mha__glu_gated_glu__prompt_kernel_od2
    v_xor_b32 v99, s61, v99
    v_xor_b32 v103, s61, v103
    v_xor_b32 v107, s61, v107
    v_xor_b32 v111, s61, v111
    v_or3_b32 v4, v99, v103, v107
    v_or_b32 v4, v4, v111
    v_cmp_lt_u32 vcc, s5, v4
    s_cbranch_vccnz sequential_preLN__softmax_full_mha__glu_gated_glu__prompt_kernel_os2
    s_branch sequential_preLN__softmax_full_mha__glu_gated_glu__prompt_kernel_od2
sequential_preLN__softmax_full_mha__glu_gated_glu__prompt_kernel_or3:
    s_mov_b32 s63, 65536
sequential_preLN__softmax_full_mha__glu_gated_glu__prompt_kernel_os3:
    buffer_load_dwordx4 v[112:115], v2, s[32:35], s15 offen offset:0 sc1
    buffer_load_dwordx4 v[116:119], v0, s[32:35], s15 offen offset:0 sc1
    buffer_load_dwordx4 v[120:123], v2, s[32:35], s15 offen offset:1024 sc1
    buffer_load_dwordx4 v[124:127], v0, s[32:35], s15 offen offset:1024 sc1
    s_waitcnt vmcnt(4)
    s_sub_u32 s63, s63, 1
    s_waitcnt vmcnt(0)
    s_cbranch_scc1 sequential_preLN__softmax_full_mha__glu_gated_glu__prompt_kernel_od3
    v_xor_b32 v115, s61, v115
    v_xor_b32 v119, s61, v119
    v_xor_b32 v123, s61, v123
    v_xor_b32 v127, s61, v127
    v_or3_b32 v4, v115, v119, v123
    v_or_b32 v4, v4, v127
    v_cmp_lt_u32 vcc, s5, v4
    s_cbranch_vccnz sequential_preLN__softmax_full_mha__glu_gated_glu__prompt_kernel_os3
    s_branch sequential_preLN__softmax_full_mha__glu_gated_glu__prompt_kernel_od3
sequential_preLN__softmax_full_mha__glu_gated_glu__prompt_kernel_fbr:
    s_mov_b32 s63, 65536
sequential_preLN__softmax_full_mha__glu_gated_glu__prompt_kernel_fbc:
    buffer_load_dword v23, v20, s[32:35], s4 offen offset:0 sc1
    s_sub_u32 s63, s63, 1
    s_waitcnt vmcnt(0)
    v_cmp_ne_u32 vcc, s44, v23
    s_cbranch_vccz sequential_preLN__softmax_full_mha__glu_gated_glu__prompt_kernel_fbd
    s_cbranch_scc0 sequential_preLN__softmax_full_mha__glu_gated_glu__prompt_kernel_fbc
    s_branch sequential_preLN__softmax_full_mha__glu_gated_glu__prompt_kernel_fbd
sequential_preLN__softmax_full_mha__glu_gated_glu__prompt_kernel_sb7a:
    buffer_store_dwordx4 v[80:83], v2, s[40:43], s59 offen offset:0 sc1
    s_branch sequential_preLN__softmax_full_mha__glu_gated_glu__prompt_kernel_sb7b
sequential_preLN__softmax_full_mha__glu_gated_glu__prompt_kernel_sb8a:
    buffer_store_dwordx4 v[84:87], v2, s[40:43], s62 offen offset:0 sc1
    s_branch sequential_preLN__softmax_full_mha__glu_gated_glu__prompt_kernel_sb8b
sequential_preLN__softmax_full_mha__glu_gated_glu__prompt_kernel_sb9a:
    buffer_store_dword v4, v21, s[40:43], s16 offen offset:0 sc1
    s_branch sequential_preLN__softmax_full_mha__glu_gated_glu__prompt_kernel_sb9b
sequential_preLN__softmax_full_mha__glu_gated_glu__prompt_kernel_sb10a:
    buffer_store_dword v30, v31, s[40:43], s5 offen offset:0 sc1
    s_branch sequential_preLN__softmax_full_mha__glu_gated_glu__prompt_kernel_sb10b
sequential_preLN__softmax_full_mha__glu_gated_glu__prompt_kernel_sb11a:
    buffer_store_dwordx4 v[16:19], v2, s[40:43], s53 offen offset:0 sc1
    s_branch sequential_preLN__softmax_full_mha__glu_gated_glu__prompt_kernel_sb11b
sequential_preLN__softmax_full_mha__glu_gated_glu__prompt_kernel_sb12a:
    buffer_store_dword v30, v31, s[40:43], s58 offen offset:0 sc1
    s_branch sequential_preLN__softmax_full_mha__glu_gated_glu__prompt_kernel_sb12b
sequential_preLN__softmax_full_mha__glu_gated_glu__prompt_kernel_f1r:
    s_mov_b32 s63, 65536
sequential_preLN__softmax_full_mha__glu_gated_glu__prompt_kernel_f1c:
    buffer_load_dword v23, v22, s[32:35], s17 offen offset:0 sc1
    s_sub_u32 s63, s63, 1
    s_waitcnt vmcnt(0)
    v_cmp_ne_u32 vcc, s44, v23
    s_cbranch_vccz sequential_preLN__softmax_full_mha__glu_gated_glu__prompt_kernel_f1d
    s_cbranch_scc0 sequential_preLN__softmax_full_mha__glu_gated_glu__prompt_kernel_f1c
    s_branch sequential_preLN__softmax_full_mha__glu_gated_glu__prompt_kernel_f1d
sequential_preLN__softmax_full_mha__glu_gated_glu__prompt_kernel_f2r:
    s_mov_b32 s63, 65536
sequential_preLN__softmax_full_mha__glu_gated_glu__prompt_kernel_f2c:
    buffer_load_dword v23, v21, s[32:35], s16 offen offset:256 sc1
    s_sub_u32 s63, s63, 1
    s_waitcnt vmcnt(0)
    v_cmp_ne_u32 vcc, s44, v23
    s_cbranch_vccz sequential_preLN__softmax_full_mha__glu_gated_glu__prompt_kernel_f2d
    s_cbranch_scc0 sequential_preLN__softmax_full_mha__glu_gated_glu__prompt_kernel_f2c
    s_branch sequential_preLN__softmax_full_mha__glu_gated_glu__prompt_kernel_f2d
sequential_preLN__softmax_full_mha__glu_gated_glu__prompt_kernel_f3r:
    s_mov_b32 s63, 65536
sequential_preLN__softmax_full_mha__glu_gated_glu__prompt_kernel_f3c:
    buffer_load_dword v23, v21, s[32:35], s16 offen offset:1024 sc1
    s_sub_u32 s63, s63, 1
    s_waitcnt vmcnt(0)
    v_cmp_ne_u32 vcc, s44, v23
    s_cbranch_vccz sequential_preLN__softmax_full_mha__glu_gated_glu__prompt_kernel_f3d
    s_cbranch_scc0 sequential_preLN__softmax_full_mha__glu_gated_glu__prompt_kernel_f3c
    s_branch sequential_preLN__softmax_full_mha__glu_gated_glu__prompt_kernel_f3d
sequential_preLN__softmax_full_mha__glu_gated_glu__prompt_kernel_sb13a:
    buffer_store_dword v30, v31, s[40:43], s58 offen offset:1024 sc1
    s_branch sequential_preLN__softmax_full_mha__glu_gated_glu__prompt_kernel_sb13b
sequential_preLN__softmax_full_mha__glu_gated_glu__prompt_kernel_f0r:
    s_mov_b32 s63, 65536
sequential_preLN__softmax_full_mha__glu_gated_glu__prompt_kernel_f0c:
    buffer_load_dword v23, v21, s[32:35], s16 offen offset:1280 sc1
    s_sub_u32 s63, s63, 1
    s_waitcnt vmcnt(0)
    v_cmp_ne_u32 vcc, s44, v23
    s_cbranch_vccz sequential_preLN__softmax_full_mha__glu_gated_glu__prompt_kernel_f0d
    s_cbranch_scc0 sequential_preLN__softmax_full_mha__glu_gated_glu__prompt_kernel_f0c
    s_branch sequential_preLN__softmax_full_mha__glu_gated_glu__prompt_kernel_f0d
sequential_preLN__softmax_full_mha__glu_gated_glu__prompt_kernel_sb14a:
    buffer_store_dword v30, v31, s[40:43], s58 offen offset:1280 sc1
    s_branch sequential_preLN__softmax_full_mha__glu_gated_glu__prompt_kernel_sb14b
sequential_preLN__softmax_full_mha__glu_gated_glu__prompt_kernel_sb15a:
    buffer_store_dwordx4 v[16:19], v2, s[40:43], s53 offen offset:0 sc1
    s_branch sequential_preLN__softmax_full_mha__glu_gated_glu__prompt_kernel_sb15b
sequential_preLN__softmax_full_mha__glu_gated_glu__prompt_kernel_sb16a:
    buffer_store_dword v30, v31, s[40:43], s58 offen offset:256 sc1
    s_branch sequential_preLN__softmax_full_mha__glu_gated_glu__prompt_kernel_sb16b
.section .rodata,"a"
.p2align 6
.amdhsa_kernel sequential_preLN__softmax_full_mha__glu_gated_glu__prompt_kernel
  .amdhsa_next_free_vgpr 512
  .amdhsa_next_free_sgpr 102
  .amdhsa_accum_offset 256
  .amdhsa_group_segment_fixed_size 0
  .amdhsa_kernarg_size 80
  .amdhsa_user_sgpr_count 2
  .amdhsa_user_sgpr_kernarg_segment_ptr 1
  .amdhsa_system_sgpr_workgroup_id_x 1
.end_amdhsa_kernel
```
